```python
import torch

def _softmax(x, axis=-1):
    return torch.softmax(x, dim=axis)
def _gelu(x):
    return torch.nn.functional.gelu(x, approximate="tanh")
def _silu(x):
    return torch.nn.functional.silu(x)
def _sigmoid(x):
    return torch.sigmoid(x)
def _layernorm(x, axis=-1, eps=1e-5):
    m = x.mean(dim=axis, keepdim=True)
    v = x.var(dim=axis, keepdim=True, unbiased=False)
    return (x - m) / torch.sqrt(v + eps)
def _scatter_add(tgt, idx, src, axis=0):
    return tgt.clone().index_add_(axis, idx, src)
def _segment_sum(src, seg, n):
    out = torch.zeros((n,) + src.shape[1:], dtype=src.dtype)
    return out.index_add_(0, seg, src)
def _pad(x, pw):
    flat = tuple(v for pair in reversed(pw) for v in pair)
    return torch.nn.functional.pad(x, flat)

kernel_name = 'sequential_preLN__spectral_fnet__dense_activation_relu__prompt'

def setup_inputs():

    _w = (lambda a: (lambda t: t.to(torch.bfloat16) if t.is_floating_point() else t)(torch.as_tensor(a)))
    def _A_setup():
        B, S, D = 1, 2048, 448
        ns = torch.arange(S)[:, None] * torch.arange(S)[None, :]
        nd = torch.arange(D)[:, None] * torch.arange(D)[None, :]
        Ws_re = torch.cos(-2.0 * torch.pi * ns / S).to(float)
        Ws_im = torch.sin(-2.0 * torch.pi * ns / S).to(float)
        Wd_re = torch.cos(-2.0 * torch.pi * nd / D).to(float)
        Wd_im = torch.sin(-2.0 * torch.pi * nd / D).to(float)
        return {
            "x": _w((lambda *s: torch.randn(*s, dtype=torch.bfloat16) * 0.05)(B, S, D)),
            "dft_seq_re": _w(Ws_re),
            "dft_seq_im": _w(Ws_im),
            "dft_hid_re": _w(Wd_re),
            "dft_hid_im": _w(Wd_im),
        }
    _A_in = _A_setup()

    def _B_setup():
        B, S, D, Dff = 1, 2048, 448, 1792
        return {
            "x": _w((lambda *s: torch.randn(*s, dtype=torch.bfloat16) * 0.05)(B, S, D)),
            "w1": _w((lambda *s: torch.randn(*s, dtype=torch.bfloat16) * 0.4)(D, Dff)),
            "w2": _w((lambda *s: torch.randn(*s, dtype=torch.bfloat16) * 0.4)(Dff, D)),
        }
    _B_in = _B_setup()

    return {
        "A_x": _A_in["x"],
        "A_dft_seq_re": _A_in["dft_seq_re"],
        "A_dft_seq_im": _A_in["dft_seq_im"],
        "A_dft_hid_re": _A_in["dft_hid_re"],
        "A_dft_hid_im": _A_in["dft_hid_im"],
        "B_x": _B_in["x"],
        "B_w1": _B_in["w1"],
        "B_w2": _B_in["w2"],
    }

def reference(A_x, A_dft_seq_re, A_dft_seq_im, A_dft_hid_re, A_dft_hid_im, B_x, B_w1, B_w2):
    def _A_ref(x, dft_seq_re, dft_seq_im, dft_hid_re, dft_hid_im):
        a = torch.einsum("bsd,ed->bse", x, dft_hid_re)
        b = torch.einsum("bsd,ed->bse", x, dft_hid_im)
        y = torch.einsum("ts,bse->bte", dft_seq_re, a) - torch.einsum("ts,bse->bte", dft_seq_im, b)
        return y

    def _B_ref(x, w1, w2):
        h = torch.einsum("bsd,df->bsf", x, w1)
        zero = torch.zeros_like(h)
        h = torch.maximum(h, zero)
        return torch.einsum("bsf,fd->bsd", h, w2)

    x = A_x
    h = x + _A_ref(_layernorm(x, axis=-1), A_dft_seq_re, A_dft_seq_im, A_dft_hid_re, A_dft_hid_im)
    h2 = h + _B_ref(_layernorm(h, axis=-1), B_w1, B_w2)
    return h2
```

```asm
; @launch kernel=fnet_k1_kernel grid=(252,1,1) block=(256,1,1) lds=126976
; @launch kernel=fnet_k2_kernel grid=(224,1,1) block=(256,1,1) lds=127232
.amdgcn_target "amdgcn-amd-amdhsa--gfx950"
.text
.globl fnet_k1_kernel
.p2align 8
.type fnet_k1_kernel,@function
fnet_k1_kernel:
    s_cmp_ge_u32 s2, 252
    s_cbranch_scc1 L_k1_end
    s_load_dwordx2 s[8:9], s[0:1], 0
    s_load_dwordx2 s[12:13], s[0:1], 24
    s_load_dwordx2 s[14:15], s[0:1], 32
    s_load_dwordx4 s[20:23], s[0:1], 48
    s_load_dwordx2 s[28:29], s[0:1], 80
    s_cmp_ge_u32 s2, 16
    s_cbranch_scc1 L_k1_nopf
    s_getpc_b64 s[68:69]
L_k1_pc:
    s_and_b32 s69, s69, 0xffff
    s_mov_b32 s70, L_code_end-L_k1_pc
    s_mov_b32 s71, 0x20000
    v_lshlrev_b32 v2, 6, v0
    s_mov_b32 s39, 16384
    buffer_load_dword v216, v2, s[68:71], 0 offen
    buffer_load_dword v217, v2, s[68:71], s39 offen
L_k1_nopf:
    v_and_b32 v1, 63, v0
    v_lshrrev_b32 v2, 6, v0
    s_and_b32 s40, s2, 7
    v_readfirstlane_b32 s36, v2
s_nop 0
    s_lshr_b32 s67, s36, 2
    s_and_b32 s36, s36, 3
    s_lshr_b32 s41, s2, 3
    s_mul_i32 s42, s41, 37
    s_lshr_b32 s42, s42, 8
    s_mul_i32 s43, s42, 7
    s_sub_u32 s38, s41, s43
    s_lshl_b32 s40, s40, 2
    s_add_u32 s37, s40, s42
    v_lshrrev_b32 v2, 3, v1
    v_and_b32 v3, 7, v1
    v_lshrrev_b32 v4, 1, v2
    v_xor_b32 v3, v3, v4
    v_lshlrev_b32 v3, 4, v3
    v_mul_u32_u24 v4, 28672, v2
    v_add_u32 v10, v4, v3
    v_xor_b32 v11, 64, v10
    v_mul_u32_u24 v4, 896, v2
    v_add_u32 v12, v4, v3
    v_xor_b32 v13, 64, v12
    v_lshlrev_b32 v28, 4, v1
    v_lshrrev_b32 v5, 5, v1
    v_bfe_u32 v6, v1, 4, 1
    v_and_b32 v7, 15, v1
    v_lshlrev_b32 v7, 3, v7
    s_waitcnt lgkmcnt(0)
    s_mov_b32 s10, 1835008
    s_mov_b32 s11, 0x20000
    s_cmp_ge_u32 s36, 2
    s_cselect_b32 s16, s14, s12
    s_cselect_b32 s17, s15, s13
    s_mov_b32 s18, 401408
    s_mov_b32 s19, 0x20000
    s_mov_b32 s30, 6291456
    s_mov_b32 s31, 0x20000
    s_lshr_b32 s66, s2, 3
    s_and_b32 s66, s66, 7
    s_mov_b32 s76, s8
    s_mov_b32 s77, s9
    s_cmp_eq_u32 s66, 1
    s_cselect_b32 s76, s12, s76
    s_cselect_b32 s77, s13, s77
    s_cmp_eq_u32 s66, 2
    s_cselect_b32 s76, s14, s76
    s_cselect_b32 s77, s15, s77
    s_cmp_eq_u32 s66, 3
    s_cselect_b32 s76, s20, s76
    s_cselect_b32 s77, s21, s77
    s_cmp_eq_u32 s66, 4
    s_cselect_b32 s76, s22, s76
    s_cselect_b32 s77, s23, s77
    s_cmp_eq_u32 s66, 5
    s_cselect_b32 s76, s28, s76
    s_cselect_b32 s77, s29, s77
    s_mov_b32 s78, 64
    s_mov_b32 s79, 0x20000
    v_mov_b32 v218, 0
    buffer_load_dword v219, v218, s[76:79], 0 offen
    s_cmp_ge_u32 s2, 224
    s_cbranch_scc1 L_k1_cjob
    s_mul_i32 s40, s36, 458752
    s_mul_i32 s41, s37, 896
    s_add_u32 s40, s40, s41
    s_add_u32 s41, s40, 229376
    s_and_b32 s42, s36, 1
    s_lshl_b32 s42, s42, 4
    s_lshl_b32 s43, s38, 5
    s_add_u32 s42, s42, s43
    s_add_u32 s42, s42, 1
    s_mul_i32 s42, s42, 896
    s_add_u32 s43, s42, 7168
    s_lshl_b32 s62, s36, 11
    s_lshr_b32 s63, s2, 3
    s_mul_i32 s64, s63, 37
    s_lshr_b32 s64, s64, 8
    s_lshl_b32 s64, s64, 1
    s_add_u32 s64, s64, s38
    s_cmp_ge_u32 s64, 7
    s_cselect_b32 s65, 7, 0
    s_sub_u32 s64, s64, s65
    s_cmp_ge_u32 s64, 7
    s_cselect_b32 s65, 7, 0
    s_sub_u32 s64, s64, s65
    s_lshl_b32 s64, s64, 7
    s_mov_b32 s72, s40
    s_mov_b32 s73, s41
    s_mov_b32 s74, s42
    s_mov_b32 s75, s43
    s_add_u32 m0, s62, 12288
    s_add_u32 s65, s72, s64
    buffer_load_dwordx4 v10, s[8:11], s65 offen lds
    s_add_u32 m0, s62, 69632
    s_add_u32 s65, s74, s64
    buffer_load_dwordx4 v12, s[16:19], s65 offen lds
    s_add_u32 m0, s62, 13312
    s_add_u32 s65, s73, s64
    buffer_load_dwordx4 v11, s[8:11], s65 offen lds
    s_add_u32 m0, s62, 70656
    s_add_u32 s65, s75, s64
    buffer_load_dwordx4 v13, s[16:19], s65 offen lds
    s_add_u32 s64, s64, 128
    s_cmp_eq_u32 s64, 896
    s_cselect_b32 s64, 0, s64
    s_add_u32 m0, s62, 20480
    s_add_u32 s65, s72, s64
    buffer_load_dwordx4 v10, s[8:11], s65 offen lds
    s_add_u32 m0, s62, 77824
    s_add_u32 s65, s74, s64
    buffer_load_dwordx4 v12, s[16:19], s65 offen lds
    s_add_u32 m0, s62, 21504
    s_add_u32 s65, s73, s64
    buffer_load_dwordx4 v11, s[8:11], s65 offen lds
    s_add_u32 m0, s62, 78848
    s_add_u32 s65, s75, s64
    buffer_load_dwordx4 v13, s[16:19], s65 offen lds
    s_add_u32 s64, s64, 128
    s_cmp_eq_u32 s64, 896
    s_cselect_b32 s64, 0, s64
    s_sub_u32 s44, s2, 0
    s_lshl_b32 s44, s44, 2
    s_add_u32 s44, s44, s36
    s_cmp_ge_u32 s44, 392
    s_cbranch_scc1 L_k1_w2task
    s_mul_i32 s45, s44, 4682
    s_lshr_b32 s45, s45, 16
    s_mul_i32 s46, s45, 14
    s_sub_u32 s46, s44, s46
    s_mov_b32 s24, s20
    s_mov_b32 s25, s21
    s_mul_i32 s47, s45, 57344
    s_lshl_b32 s48, s46, 8
    s_add_u32 s47, s47, s48
    s_mov_b32 s48, 28672
    s_mov_b32 s49, 128
    s_mov_b32 s50, 14336
    s_mul_i32 s51, s46, 114688
    s_lshl_b32 s52, s45, 10
    s_add_u32 s51, s51, s52
    s_add_u32 s51, s51, 2097152
    s_mov_b32 s52, 28672
    s_mov_b32 s53, 57344
    s_mov_b32 s54, 86016
    s_branch L_k1_taskld
L_k1_w2task:
    s_sub_u32 s44, s44, 392
    s_mul_i32 s45, s44, 9363
    s_lshr_b32 s45, s45, 16
    s_mul_i32 s46, s45, 7
    s_sub_u32 s46, s44, s46
    s_lshr_b32 s55, s45, 3
    s_and_b32 s56, s45, 7
    s_mov_b32 s24, s22
    s_mov_b32 s25, s23
    s_lshl_b32 s57, s55, 1
    s_lshr_b32 s58, s56, 2
    s_add_u32 s57, s57, s58
    s_lshl_b32 s57, s57, 7
    s_and_b32 s58, s56, 3
    s_add_u32 s57, s57, s58
    s_mul_i32 s47, s57, 896
    s_lshl_b32 s58, s46, 7
    s_add_u32 s47, s47, s58
    s_mov_b32 s48, 57344
    s_mov_b32 s49, 14336
    s_mov_b32 s50, 28672
    s_mul_i32 s51, s55, 28
    s_add_u32 s51, s51, s46
    s_lshl_b32 s51, s51, 3
    s_add_u32 s51, s51, s56
    s_lshl_b32 s51, s51, 10
    s_add_u32 s51, s51, 4194304
    s_mov_b32 s52, 57344
    s_mov_b32 s53, 114688
    s_mov_b32 s54, 172032
L_k1_taskld:
    s_cmp_ge_u32 s2, 196
    s_cselect_b32 s26, 0, 1605632
    s_cselect_b32 s34, 0, 6291456
    s_mov_b32 s27, 0x20000
    s_mov_b32 s32, s28
    s_mov_b32 s33, s29
    s_mov_b32 s35, 0x20000
    v_mul_lo_u32 v8, v5, s48
    v_mul_lo_u32 v9, v6, s49
    v_add3_u32 v27, v8, v9, v7
    s_add_u32 s50, s50, s47
    s_getpc_b64 s[80:81]
L_k1_pc3:
    s_add_u32 s80, s80, L_cs_table-L_k1_pc3
    s_addc_u32 s81, s81, 0
    s_and_b32 s81, s81, 0xffff
    s_mov_b32 s82, 1792
    s_mov_b32 s83, 0x20000
    s_lshr_b32 s44, s36, 1
    s_mul_i32 s44, s44, 224
    s_lshl_b32 s45, s38, 5
    s_add_u32 s44, s44, s45
    s_lshl_b32 s44, s44, 2
    v_and_b32 v2, 31, v1
    v_lshlrev_b32 v2, 2, v2
    buffer_load_dword v30, v2, s[80:83], s44 offen
    v_and_b32 v2, 31, v1
    s_and_b32 s40, s36, 1
    s_lshr_b32 s41, s36, 1
    v_lshrrev_b32 v3, 3, v2
    v_lshlrev_b32 v3, 10, v3
    v_and_b32 v4, 7, v2
    v_lshlrev_b32 v4, 7, v4
    v_add_u32 v3, v3, v4
    v_bfe_u32 v4, v2, 1, 3
    s_lshl_b32 s42, s40, 12
    s_add_u32 s42, s42, 12288
    v_add_u32 v3, s42, v3
    s_sub_u32 s43, s41, s40
    s_lshl_b32 s43, s43, 12
    s_add_u32 s43, s43, 57344
    s_xor_b32 s44, s41, 0
    s_lshl_b32 s44, s44, 1
    v_add_u32 v6, s44, v5
    v_xor_b32 v6, v6, v4
    v_lshl_add_u32 v14, v6, 4, v3
    v_add_u32 v18, s43, v14
    s_xor_b32 s44, s41, 1
    s_lshl_b32 s44, s44, 1
    v_add_u32 v6, s44, v5
    v_xor_b32 v6, v6, v4
    v_lshl_add_u32 v15, v6, 4, v3
    v_add_u32 v19, s43, v15
    s_xor_b32 s44, s41, 2
    s_lshl_b32 s44, s44, 1
    v_add_u32 v6, s44, v5
    v_xor_b32 v6, v6, v4
    v_lshl_add_u32 v16, v6, 4, v3
    v_add_u32 v20, s43, v16
    s_xor_b32 s44, s41, 3
    s_lshl_b32 s44, s44, 1
    v_add_u32 v6, s44, v5
    v_xor_b32 v6, v6, v4
    v_lshl_add_u32 v17, v6, 4, v3
    v_add_u32 v21, s43, v17
    v_mov_b32 v22, 0x3f803f80
    v_mov_b32 v23, 0
    v_mov_b32 v24, 0
    v_and_b32 v2, 15, v1
    s_lshl_b32 s44, s36, 4
    v_add_u32 v6, s44, v2
    v_cvt_f32_u32 v6, v6
    v_mul_f32 v6, 0x3c800000, v6
    v_lshrrev_b32 v7, 5, v1
    v_lshlrev_b32 v7, 4, v7
    v_bfe_u32 v8, v1, 4, 1
    v_lshl_add_u32 v7, v8, 2, v7
    v_cvt_f32_u32 v7, v7
    v_mul_f32 v7, v6, v7
    v_and_b32 v8, 1, v1
    v_mul_u32_u24 v8, 0x8000, v8
    v_lshl_or_b32 v25, v8, 16, v8
    v_fmamk_f32 v2, v6, 0x00000000, v7
    v_fmamk_f32 v3, v6, 0x3f800000, v7
    v_cos_f32 v8, v2
    v_cos_f32 v9, v3
    v_sin_f32 v2, v2
    v_sin_f32 v3, v3
    v_cvt_pk_bf16_f32 v120, v8, v9
    v_cvt_pk_bf16_f32 v124, v2, v3
    v_fmamk_f32 v2, v6, 0x40000000, v7
    v_fmamk_f32 v3, v6, 0x40400000, v7
    v_cos_f32 v8, v2
    v_cos_f32 v9, v3
    v_sin_f32 v2, v2
    v_sin_f32 v3, v3
    v_cvt_pk_bf16_f32 v121, v8, v9
    v_cvt_pk_bf16_f32 v125, v2, v3
    v_fmamk_f32 v2, v6, 0x41000000, v7
    v_fmamk_f32 v3, v6, 0x41100000, v7
    v_cos_f32 v8, v2
    v_cos_f32 v9, v3
    v_sin_f32 v2, v2
    v_sin_f32 v3, v3
    v_cvt_pk_bf16_f32 v122, v8, v9
    v_cvt_pk_bf16_f32 v126, v2, v3
    v_fmamk_f32 v2, v6, 0x41200000, v7
    v_fmamk_f32 v3, v6, 0x41300000, v7
    v_cos_f32 v8, v2
    v_cos_f32 v9, v3
    v_sin_f32 v2, v2
    v_sin_f32 v3, v3
    v_cvt_pk_bf16_f32 v123, v8, v9
    v_cvt_pk_bf16_f32 v127, v2, v3
    v_xor_b32 v128, v25, v120
    v_xor_b32 v132, v25, v124
    v_xor_b32 v136, 0x80008000, v124
    v_xor_b32 v140, 0x80008000, v132
    v_xor_b32 v129, v25, v121
    v_xor_b32 v133, v25, v125
    v_xor_b32 v137, 0x80008000, v125
    v_xor_b32 v141, 0x80008000, v133
    v_xor_b32 v130, v25, v122
    v_xor_b32 v134, v25, v126
    v_xor_b32 v138, 0x80008000, v126
    v_xor_b32 v142, 0x80008000, v134
    v_xor_b32 v131, v25, v123
    v_xor_b32 v135, v25, v127
    v_xor_b32 v139, 0x80008000, v127
    v_xor_b32 v143, 0x80008000, v135
    v_and_b32 v2, 15, v1
    v_lshlrev_b32 v3, 4, v2
    v_bfe_u32 v4, v1, 4, 1
    v_lshl_add_u32 v3, v4, 9, v3
    v_lshrrev_b32 v4, 5, v1
    v_lshl_add_u32 v3, v4, 10, v3
    v_add_u32 v26, 4096, v3
    v_lshrrev_b32 v4, 4, v1
    v_mul_u32_u24 v4, 114688, v4
    v_lshl_add_u32 v29, v2, 2, v4
    s_add_u32 m0, s62, 28672
    s_add_u32 s65, s72, s64
    buffer_load_dwordx4 v10, s[8:11], s65 offen lds
    s_add_u32 m0, s62, 86016
    s_add_u32 s65, s74, s64
    buffer_load_dwordx4 v12, s[16:19], s65 offen lds
    s_add_u32 m0, s62, 29696
    s_add_u32 s65, s73, s64
    buffer_load_dwordx4 v11, s[8:11], s65 offen lds
    s_add_u32 m0, s62, 87040
    s_add_u32 s65, s75, s64
    buffer_load_dwordx4 v13, s[16:19], s65 offen lds
    s_add_u32 s64, s64, 128
    s_cmp_eq_u32 s64, 896
    s_cselect_b32 s64, 0, s64
    s_add_u32 m0, s62, 36864
    s_add_u32 s65, s72, s64
    buffer_load_dwordx4 v10, s[8:11], s65 offen lds
    s_add_u32 m0, s62, 94208
    s_add_u32 s65, s74, s64
    buffer_load_dwordx4 v12, s[16:19], s65 offen lds
    s_add_u32 m0, s62, 37888
    s_add_u32 s65, s73, s64
    buffer_load_dwordx4 v11, s[8:11], s65 offen lds
    s_add_u32 m0, s62, 95232
    s_add_u32 s65, s75, s64
    buffer_load_dwordx4 v13, s[16:19], s65 offen lds
    s_add_u32 s64, s64, 128
    s_cmp_eq_u32 s64, 896
    s_cselect_b32 s64, 0, s64
    s_add_u32 m0, s62, 45056
    s_add_u32 s65, s72, s64
    buffer_load_dwordx4 v10, s[8:11], s65 offen lds
    s_add_u32 m0, s62, 102400
    s_add_u32 s65, s74, s64
    buffer_load_dwordx4 v12, s[16:19], s65 offen lds
    s_add_u32 m0, s62, 46080
    s_add_u32 s65, s73, s64
    buffer_load_dwordx4 v11, s[8:11], s65 offen lds
    s_add_u32 m0, s62, 103424
    s_add_u32 s65, s75, s64
    buffer_load_dwordx4 v13, s[16:19], s65 offen lds
    s_add_u32 s64, s64, 128
    s_cmp_eq_u32 s64, 896
    s_cselect_b32 s64, 0, s64
    s_waitcnt vmcnt(17)
    s_barrier
    ds_read_b128 v[32:35], v14 offset:0
    ds_read_b128 v[48:51], v16 offset:0
    ds_read_b128 v[40:43], v15 offset:0
    ds_read_b128 v[56:59], v17 offset:0
    ds_read_b128 v[36:39], v18 offset:0
    ds_read_b128 v[44:47], v19 offset:0
    ds_read_b128 v[52:55], v20 offset:0
    ds_read_b128 v[60:63], v21 offset:0
    s_add_u32 m0, s62, 53248
    s_add_u32 s65, s72, s64
    buffer_load_dwordx4 v10, s[8:11], s65 offen lds
    s_add_u32 m0, s62, 110592
    s_add_u32 s65, s74, s64
    buffer_load_dwordx4 v12, s[16:19], s65 offen lds
    s_add_u32 m0, s62, 54272
    s_add_u32 s65, s73, s64
    buffer_load_dwordx4 v11, s[8:11], s65 offen lds
    s_add_u32 m0, s62, 111616
    s_add_u32 s65, s75, s64
    buffer_load_dwordx4 v13, s[16:19], s65 offen lds
    s_add_u32 s64, s64, 128
    s_cmp_eq_u32 s64, 896
    s_cselect_b32 s64, 0, s64
    s_waitcnt lgkmcnt(7)
    v_dot2c_f32_bf16 v23, v32, v32
    v_dot2c_f32_bf16 v24, v32, v22
    v_dot2c_f32_bf16 v23, v33, v33
    v_dot2c_f32_bf16 v24, v33, v22
    v_dot2c_f32_bf16 v23, v34, v34
    v_dot2c_f32_bf16 v24, v34, v22
    v_dot2c_f32_bf16 v23, v35, v35
    v_dot2c_f32_bf16 v24, v35, v22
    s_waitcnt lgkmcnt(6)
    v_dot2c_f32_bf16 v23, v48, v48
    v_dot2c_f32_bf16 v24, v48, v22
    v_dot2c_f32_bf16 v23, v49, v49
    v_dot2c_f32_bf16 v24, v49, v22
    v_dot2c_f32_bf16 v23, v50, v50
    v_dot2c_f32_bf16 v24, v50, v22
    v_dot2c_f32_bf16 v23, v51, v51
    v_dot2c_f32_bf16 v24, v51, v22
    s_waitcnt vmcnt(17)
    s_barrier
    s_waitcnt lgkmcnt(0)
    v_mfma_f32_32x32x16_bf16 v[96:111], v[32:35], v[36:39], 0
    ds_read_b128 v[184:187], v14 offset:8192
    ds_read_b128 v[200:203], v16 offset:8192
    s_add_u32 m0, s62, 61440
    s_add_u32 s65, s72, s64
    buffer_load_dwordx4 v10, s[8:11], s65 offen lds
    v_mfma_f32_32x32x16_bf16 v[96:111], v[40:43], v[44:47], v[96:111]
    ds_read_b128 v[192:195], v15 offset:8192
    ds_read_b128 v[208:211], v17 offset:8192
    s_add_u32 m0, s62, 118784
    s_add_u32 s65, s74, s64
    buffer_load_dwordx4 v12, s[16:19], s65 offen lds
    v_mfma_f32_32x32x16_bf16 v[96:111], v[48:51], v[52:55], v[96:111]
    ds_read_b128 v[188:191], v18 offset:8192
    ds_read_b128 v[196:199], v19 offset:8192
    s_add_u32 m0, s62, 62464
    s_add_u32 s65, s73, s64
    buffer_load_dwordx4 v11, s[8:11], s65 offen lds
    v_mfma_f32_32x32x16_bf16 v[96:111], v[56:59], v[60:63], v[96:111]
    ds_read_b128 v[204:207], v20 offset:8192
    ds_read_b128 v[212:215], v21 offset:8192
    s_add_u32 m0, s62, 119808
    s_add_u32 s65, s75, s64
    buffer_load_dwordx4 v13, s[16:19], s65 offen lds
    s_waitcnt lgkmcnt(7)
    v_dot2c_f32_bf16 v23, v184, v184
    v_dot2c_f32_bf16 v24, v184, v22
    v_dot2c_f32_bf16 v23, v185, v185
    v_dot2c_f32_bf16 v24, v185, v22
    v_dot2c_f32_bf16 v23, v186, v186
    v_dot2c_f32_bf16 v24, v186, v22
    v_dot2c_f32_bf16 v23, v187, v187
    v_dot2c_f32_bf16 v24, v187, v22
    s_waitcnt lgkmcnt(6)
    v_dot2c_f32_bf16 v23, v200, v200
    v_dot2c_f32_bf16 v24, v200, v22
    v_dot2c_f32_bf16 v23, v201, v201
    v_dot2c_f32_bf16 v24, v201, v22
    v_dot2c_f32_bf16 v23, v202, v202
    v_dot2c_f32_bf16 v24, v202, v22
    v_dot2c_f32_bf16 v23, v203, v203
    v_dot2c_f32_bf16 v24, v203, v22
    s_waitcnt vmcnt(16)
    s_barrier
    s_waitcnt lgkmcnt(0)
    v_mfma_f32_32x32x16_bf16 v[96:111], v[184:187], v[188:191], v[96:111]
    ds_read_b128 v[32:35], v14 offset:16384
    ds_read_b128 v[48:51], v16 offset:16384
    buffer_load_dwordx2 v[64:65], v27, s[24:27], s47 offen
    v_mfma_f32_32x32x16_bf16 v[96:111], v[192:195], v[196:199], v[96:111]
    ds_read_b128 v[40:43], v15 offset:16384
    ds_read_b128 v[56:59], v17 offset:16384
    s_add_u32 s59, s47, 3584
    buffer_load_dwordx2 v[66:67], v27, s[24:27], s59 offen
    v_mfma_f32_32x32x16_bf16 v[96:111], v[200:203], v[204:207], v[96:111]
    ds_read_b128 v[36:39], v18 offset:16384
    ds_read_b128 v[44:47], v19 offset:16384
    s_add_u32 s59, s47, 7168
    buffer_load_dwordx2 v[68:69], v27, s[24:27], s59 offen
    v_mfma_f32_32x32x16_bf16 v[96:111], v[208:211], v[212:215], v[96:111]
    ds_read_b128 v[52:55], v20 offset:16384
    ds_read_b128 v[60:63], v21 offset:16384
    s_waitcnt lgkmcnt(7)
    v_dot2c_f32_bf16 v23, v32, v32
    v_dot2c_f32_bf16 v24, v32, v22
    v_dot2c_f32_bf16 v23, v33, v33
    v_dot2c_f32_bf16 v24, v33, v22
    v_dot2c_f32_bf16 v23, v34, v34
    v_dot2c_f32_bf16 v24, v34, v22
    v_dot2c_f32_bf16 v23, v35, v35
    v_dot2c_f32_bf16 v24, v35, v22
    s_waitcnt lgkmcnt(6)
    v_dot2c_f32_bf16 v23, v48, v48
    v_dot2c_f32_bf16 v24, v48, v22
    v_dot2c_f32_bf16 v23, v49, v49
    v_dot2c_f32_bf16 v24, v49, v22
    v_dot2c_f32_bf16 v23, v50, v50
    v_dot2c_f32_bf16 v24, v50, v22
    v_dot2c_f32_bf16 v23, v51, v51
    v_dot2c_f32_bf16 v24, v51, v22
    s_waitcnt vmcnt(15)
    s_barrier
    s_waitcnt lgkmcnt(0)
    v_mfma_f32_32x32x16_bf16 v[96:111], v[32:35], v[36:39], v[96:111]
    ds_read_b128 v[184:187], v14 offset:24576
    ds_read_b128 v[200:203], v16 offset:24576
    s_add_u32 s59, s47, 10752
    buffer_load_dwordx2 v[70:71], v27, s[24:27], s59 offen
    v_mfma_f32_32x32x16_bf16 v[96:111], v[40:43], v[44:47], v[96:111]
    ds_read_b128 v[192:195], v15 offset:24576
    ds_read_b128 v[208:211], v17 offset:24576
    buffer_load_dwordx2 v[72:73], v27, s[24:27], s50 offen
    v_mfma_f32_32x32x16_bf16 v[96:111], v[48:51], v[52:55], v[96:111]
    ds_read_b128 v[188:191], v18 offset:24576
    ds_read_b128 v[196:199], v19 offset:24576
    s_add_u32 s59, s50, 3584
    buffer_load_dwordx2 v[74:75], v27, s[24:27], s59 offen
    v_mfma_f32_32x32x16_bf16 v[96:111], v[56:59], v[60:63], v[96:111]
    ds_read_b128 v[204:207], v20 offset:24576
    ds_read_b128 v[212:215], v21 offset:24576
    s_waitcnt lgkmcnt(7)
    v_dot2c_f32_bf16 v23, v184, v184
    v_dot2c_f32_bf16 v24, v184, v22
    v_dot2c_f32_bf16 v23, v185, v185
    v_dot2c_f32_bf16 v24, v185, v22
    v_dot2c_f32_bf16 v23, v186, v186
    v_dot2c_f32_bf16 v24, v186, v22
    v_dot2c_f32_bf16 v23, v187, v187
    v_dot2c_f32_bf16 v24, v187, v22
    s_waitcnt lgkmcnt(6)
    v_dot2c_f32_bf16 v23, v200, v200
    v_dot2c_f32_bf16 v24, v200, v22
    v_dot2c_f32_bf16 v23, v201, v201
    v_dot2c_f32_bf16 v24, v201, v22
    v_dot2c_f32_bf16 v23, v202, v202
    v_dot2c_f32_bf16 v24, v202, v22
    v_dot2c_f32_bf16 v23, v203, v203
    v_dot2c_f32_bf16 v24, v203, v22
    s_waitcnt vmcnt(14)
    s_barrier
    s_waitcnt lgkmcnt(0)
    v_mfma_f32_32x32x16_bf16 v[96:111], v[184:187], v[188:191], v[96:111]
    ds_read_b128 v[32:35], v14 offset:32768
    ds_read_b128 v[48:51], v16 offset:32768
    s_add_u32 s59, s50, 7168
    buffer_load_dwordx2 v[76:77], v27, s[24:27], s59 offen
    v_mfma_f32_32x32x16_bf16 v[96:111], v[192:195], v[196:199], v[96:111]
    ds_read_b128 v[40:43], v15 offset:32768
    ds_read_b128 v[56:59], v17 offset:32768
    s_add_u32 s59, s50, 10752
    buffer_load_dwordx2 v[78:79], v27, s[24:27], s59 offen
    v_mfma_f32_32x32x16_bf16 v[96:111], v[200:203], v[204:207], v[96:111]
    ds_read_b128 v[36:39], v18 offset:32768
    ds_read_b128 v[44:47], v19 offset:32768
    v_mfma_f32_32x32x16_bf16 v[96:111], v[208:211], v[212:215], v[96:111]
    ds_read_b128 v[52:55], v20 offset:32768
    ds_read_b128 v[60:63], v21 offset:32768
    s_waitcnt lgkmcnt(7)
    v_dot2c_f32_bf16 v23, v32, v32
    v_dot2c_f32_bf16 v24, v32, v22
    v_dot2c_f32_bf16 v23, v33, v33
    v_dot2c_f32_bf16 v24, v33, v22
    v_dot2c_f32_bf16 v23, v34, v34
    v_dot2c_f32_bf16 v24, v34, v22
    v_dot2c_f32_bf16 v23, v35, v35
    v_dot2c_f32_bf16 v24, v35, v22
    s_waitcnt lgkmcnt(6)
    v_dot2c_f32_bf16 v23, v48, v48
    v_dot2c_f32_bf16 v24, v48, v22
    v_dot2c_f32_bf16 v23, v49, v49
    v_dot2c_f32_bf16 v24, v49, v22
    v_dot2c_f32_bf16 v23, v50, v50
    v_dot2c_f32_bf16 v24, v50, v22
    v_dot2c_f32_bf16 v23, v51, v51
    v_dot2c_f32_bf16 v24, v51, v22
    s_waitcnt vmcnt(12)
    s_barrier
    s_waitcnt lgkmcnt(0)
    v_mfma_f32_32x32x16_bf16 v[96:111], v[32:35], v[36:39], v[96:111]
    ds_read_b128 v[184:187], v14 offset:40960
    ds_read_b128 v[200:203], v16 offset:40960
    v_mfma_f32_32x32x16_bf16 v[96:111], v[40:43], v[44:47], v[96:111]
    ds_read_b128 v[192:195], v15 offset:40960
    ds_read_b128 v[208:211], v17 offset:40960
    v_mfma_f32_32x32x16_bf16 v[96:111], v[48:51], v[52:55], v[96:111]
    ds_read_b128 v[188:191], v18 offset:40960
    ds_read_b128 v[196:199], v19 offset:40960
    v_mfma_f32_32x32x16_bf16 v[96:111], v[56:59], v[60:63], v[96:111]
    ds_read_b128 v[204:207], v20 offset:40960
    ds_read_b128 v[212:215], v21 offset:40960
    s_waitcnt lgkmcnt(7)
    v_dot2c_f32_bf16 v23, v184, v184
    v_dot2c_f32_bf16 v24, v184, v22
    v_dot2c_f32_bf16 v23, v185, v185
    v_dot2c_f32_bf16 v24, v185, v22
    v_dot2c_f32_bf16 v23, v186, v186
    v_dot2c_f32_bf16 v24, v186, v22
    v_dot2c_f32_bf16 v23, v187, v187
    v_dot2c_f32_bf16 v24, v187, v22
    s_waitcnt lgkmcnt(6)
    v_dot2c_f32_bf16 v23, v200, v200
    v_dot2c_f32_bf16 v24, v200, v22
    v_dot2c_f32_bf16 v23, v201, v201
    v_dot2c_f32_bf16 v24, v201, v22
    v_dot2c_f32_bf16 v23, v202, v202
    v_dot2c_f32_bf16 v24, v202, v22
    v_dot2c_f32_bf16 v23, v203, v203
    v_dot2c_f32_bf16 v24, v203, v22
    s_waitcnt vmcnt(8)
    s_barrier
    s_waitcnt lgkmcnt(0)
    v_mfma_f32_32x32x16_bf16 v[96:111], v[184:187], v[188:191], v[96:111]
    ds_read_b128 v[32:35], v14 offset:49152
    ds_read_b128 v[48:51], v16 offset:49152
    v_mfma_f32_32x32x16_bf16 v[96:111], v[192:195], v[196:199], v[96:111]
    ds_read_b128 v[40:43], v15 offset:49152
    ds_read_b128 v[56:59], v17 offset:49152
    v_mfma_f32_32x32x16_bf16 v[96:111], v[200:203], v[204:207], v[96:111]
    ds_read_b128 v[36:39], v18 offset:49152
    ds_read_b128 v[44:47], v19 offset:49152
    v_mfma_f32_32x32x16_bf16 v[96:111], v[208:211], v[212:215], v[96:111]
    ds_read_b128 v[52:55], v20 offset:49152
    ds_read_b128 v[60:63], v21 offset:49152
    s_waitcnt lgkmcnt(7)
    v_dot2c_f32_bf16 v23, v32, v32
    v_dot2c_f32_bf16 v24, v32, v22
    v_dot2c_f32_bf16 v23, v33, v33
    v_dot2c_f32_bf16 v24, v33, v22
    v_dot2c_f32_bf16 v23, v34, v34
    v_dot2c_f32_bf16 v24, v34, v22
    v_dot2c_f32_bf16 v23, v35, v35
    v_dot2c_f32_bf16 v24, v35, v22
    s_waitcnt lgkmcnt(6)
    v_dot2c_f32_bf16 v23, v48, v48
    v_dot2c_f32_bf16 v24, v48, v22
    v_dot2c_f32_bf16 v23, v49, v49
    v_dot2c_f32_bf16 v24, v49, v22
    v_dot2c_f32_bf16 v23, v50, v50
    v_dot2c_f32_bf16 v24, v50, v22
    v_dot2c_f32_bf16 v23, v51, v51
    v_dot2c_f32_bf16 v24, v51, v22
    v_and_b32 v2, 31, v1
    s_lshl_b32 s44, s40, 5
    v_add_u32 v2, s44, v2
    v_lshlrev_b32 v3, 5, v2
    s_lshl_b32 s44, s41, 4
    v_lshl_add_u32 v4, v5, 3, v3
    v_add_u32 v4, s44, v4
    v_mov_b32 v6, v23
    v_mov_b32 v7, v24
    ds_write_b64 v4, v[6:7] offset:0
    s_waitcnt lgkmcnt(4)
    v_mfma_f32_32x32x16_bf16 v[96:111], v[32:35], v[36:39], v[96:111]
    s_waitcnt lgkmcnt(3)
    v_mfma_f32_32x32x16_bf16 v[96:111], v[40:43], v[44:47], v[96:111]
    s_waitcnt lgkmcnt(2)
    v_mfma_f32_32x32x16_bf16 v[96:111], v[48:51], v[52:55], v[96:111]
    s_waitcnt lgkmcnt(1)
    v_mfma_f32_32x32x16_bf16 v[96:111], v[56:59], v[60:63], v[96:111]
    s_waitcnt lgkmcnt(0)
    s_barrier
    ds_read_b128 v[32:35], v3 offset:0
    ds_read_b128 v[36:39], v3 offset:16
    v_and_b32 v2, 31, v1
    s_lshl_b32 s44, s36, 7
    v_lshl_add_u32 v8, v2, 2, s44
    v_lshl_add_u32 v9, v5, 4, s44
    s_waitcnt lgkmcnt(0)
    v_add_f32 v32, v32, v34
    v_add_f32 v36, v36, v38
    v_add_f32 v33, v33, v35
    v_add_f32 v37, v37, v39
    v_add_f32 v32, v32, v36
    v_add_f32 v33, v33, v37
    v_mul_f32 v33, 0x3b124925, v33
    v_mul_f32 v32, 0x3b124925, v32
    v_fma_f32 v32, -v33, v33, v32
    v_add_f32 v32, 0x3727c5ac, v32
    v_rsq_f32 v32, v32
    s_nop 0
    ds_write_b32 v8, v32 offset:2048
    v_mul_f32 v33, v32, v33
    ds_write_b32 v8, v33 offset:2560
    s_waitcnt lgkmcnt(0)
    ds_read_b128 v[160:163], v9 offset:2048
    ds_read_b128 v[164:167], v9 offset:2080
    ds_read_b128 v[168:171], v9 offset:2112
    ds_read_b128 v[172:175], v9 offset:2144
    ds_read_b128 v[184:187], v9 offset:2560
    ds_read_b128 v[188:191], v9 offset:2592
    ds_read_b128 v[192:195], v9 offset:2624
    ds_read_b128 v[196:199], v9 offset:2656
    s_waitcnt lgkmcnt(4)
    v_mul_f32 v96, v96, v160
    v_mul_f32 v97, v97, v161
    v_mul_f32 v98, v98, v162
    v_mul_f32 v99, v99, v163
    v_mul_f32 v100, v100, v164
    v_mul_f32 v101, v101, v165
    v_mul_f32 v102, v102, v166
    v_mul_f32 v103, v103, v167
    v_mul_f32 v104, v104, v168
    v_mul_f32 v105, v105, v169
    v_mul_f32 v106, v106, v170
    v_mul_f32 v107, v107, v171
    v_mul_f32 v108, v108, v172
    v_mul_f32 v109, v109, v173
    v_mul_f32 v110, v110, v174
    v_mul_f32 v111, v111, v175
    s_waitcnt lgkmcnt(0)
    v_fma_f32 v96, -v184, v30, v96
    v_fma_f32 v97, -v185, v30, v97
    v_fma_f32 v98, -v186, v30, v98
    v_fma_f32 v99, -v187, v30, v99
    v_fma_f32 v100, -v188, v30, v100
    v_fma_f32 v101, -v189, v30, v101
    v_fma_f32 v102, -v190, v30, v102
    v_fma_f32 v103, -v191, v30, v103
    v_fma_f32 v104, -v192, v30, v104
    v_fma_f32 v105, -v193, v30, v105
    v_fma_f32 v106, -v194, v30, v106
    v_fma_f32 v107, -v195, v30, v107
    v_fma_f32 v108, -v196, v30, v108
    v_fma_f32 v109, -v197, v30, v109
    v_fma_f32 v110, -v198, v30, v110
    v_fma_f32 v111, -v199, v30, v111
    v_cvt_pk_bf16_f32 v112, v96, v97
    v_cvt_pk_bf16_f32 v113, v98, v99
    v_cvt_pk_bf16_f32 v114, v100, v101
    v_cvt_pk_bf16_f32 v115, v102, v103
    v_cvt_pk_bf16_f32 v116, v104, v105
    v_cvt_pk_bf16_f32 v117, v106, v107
    v_cvt_pk_bf16_f32 v118, v108, v109
    v_cvt_pk_bf16_f32 v119, v110, v111
    s_lshl_b32 s44, s41, 1
    s_add_u32 s44, s44, s40
    s_lshl_b32 s44, s44, 11
    s_add_u32 s44, s44, 4096
    v_add_u32 v2, s44, v28
    ds_write_b128 v2, v[112:115]
    ds_write_b128 v2, v[116:119] offset:1024
    s_waitcnt lgkmcnt(0)
    s_barrier
    s_waitcnt vmcnt(0)
    s_mov_b32 s56, 0x05040100
    s_mov_b32 s57, 0x07060302
    v_perm_b32 v80, v66, v64, s56
    v_perm_b32 v81, v70, v68, s56
    v_perm_b32 v82, v74, v72, s56
    v_perm_b32 v83, v78, v76, s56
    v_perm_b32 v84, v66, v64, s57
    v_perm_b32 v85, v70, v68, s57
    v_perm_b32 v86, v74, v72, s57
    v_perm_b32 v87, v78, v76, s57
    v_perm_b32 v88, v67, v65, s56
    v_perm_b32 v89, v71, v69, s56
    v_perm_b32 v90, v75, v73, s56
    v_perm_b32 v91, v79, v77, s56
    v_perm_b32 v92, v67, v65, s57
    v_perm_b32 v93, v71, v69, s57
    v_perm_b32 v94, v75, v73, s57
    v_perm_b32 v95, v79, v77, s57
    s_add_u32 s52, s52, s51
    s_add_u32 s53, s53, s51
    s_add_u32 s54, s54, s51
    buffer_store_dwordx4 v[80:83], v28, s[32:35], s51 offen
    buffer_store_dwordx4 v[84:87], v28, s[32:35], s52 offen
    buffer_store_dwordx4 v[88:91], v28, s[32:35], s53 offen
    buffer_store_dwordx4 v[92:95], v28, s[32:35], s54 offen
    ds_read_b128 v[32:35], v26 offset:0
    ds_read_b128 v[36:39], v26 offset:2048
    ds_read_b128 v[40:43], v26 offset:4096
    ds_read_b128 v[44:47], v26 offset:6144
    ds_read_b128 v[48:51], v26 offset:256
    ds_read_b128 v[52:55], v26 offset:2304
    ds_read_b128 v[56:59], v26 offset:4352
    ds_read_b128 v[60:63], v26 offset:6400
    s_waitcnt lgkmcnt(7)
    v_mfma_f32_16x16x32_bf16 v[144:147], v[120:123], v[32:35], 0
    v_mfma_f32_16x16x32_bf16 v[148:151], v[136:139], v[32:35], 0
    s_waitcnt lgkmcnt(6)
    v_mfma_f32_16x16x32_bf16 v[144:147], v[128:131], v[36:39], v[144:147]
    v_mfma_f32_16x16x32_bf16 v[148:151], v[140:143], v[36:39], v[148:151]
    s_waitcnt lgkmcnt(5)
    v_mfma_f32_16x16x32_bf16 v[144:147], v[124:127], v[40:43], v[144:147]
    v_mfma_f32_16x16x32_bf16 v[148:151], v[120:123], v[40:43], v[148:151]
    s_waitcnt lgkmcnt(4)
    v_mfma_f32_16x16x32_bf16 v[144:147], v[132:135], v[44:47], v[144:147]
    v_mfma_f32_16x16x32_bf16 v[148:151], v[128:131], v[44:47], v[148:151]
    s_waitcnt lgkmcnt(3)
    v_mfma_f32_16x16x32_bf16 v[152:155], v[120:123], v[48:51], 0
    v_mfma_f32_16x16x32_bf16 v[156:159], v[136:139], v[48:51], 0
    s_waitcnt lgkmcnt(2)
    v_mfma_f32_16x16x32_bf16 v[152:155], v[128:131], v[52:55], v[152:155]
    v_mfma_f32_16x16x32_bf16 v[156:159], v[140:143], v[52:55], v[156:159]
    s_waitcnt lgkmcnt(1)
    v_mfma_f32_16x16x32_bf16 v[152:155], v[124:127], v[56:59], v[152:155]
    v_mfma_f32_16x16x32_bf16 v[156:159], v[120:123], v[56:59], v[156:159]
    s_waitcnt lgkmcnt(0)
    v_mfma_f32_16x16x32_bf16 v[152:155], v[132:135], v[60:63], v[152:155]
    v_mfma_f32_16x16x32_bf16 v[156:159], v[128:131], v[60:63], v[156:159]
    s_mul_i32 s44, s36, 458752
    s_mul_i32 s45, s37, 896
    s_add_u32 s44, s44, s45
    s_lshl_b32 s45, s38, 7
    s_add_u32 s44, s44, s45
    s_add_u32 s45, s44, 28672
    s_add_u32 s46, s44, 57344
    s_add_u32 s47, s44, 86016
    v_cvt_pk_bf16_f32 v112, v144, v148
    v_cvt_pk_bf16_f32 v113, v145, v149
    v_cvt_pk_bf16_f32 v114, v146, v150
    v_cvt_pk_bf16_f32 v115, v147, v151
    buffer_store_dword v112, v29, s[28:31], s44 offen offset:0
    buffer_store_dword v113, v29, s[28:31], s45 offen offset:0
    buffer_store_dword v114, v29, s[28:31], s46 offen offset:0
    buffer_store_dword v115, v29, s[28:31], s47 offen offset:0
    v_cvt_pk_bf16_f32 v116, v152, v156
    v_cvt_pk_bf16_f32 v117, v153, v157
    v_cvt_pk_bf16_f32 v118, v154, v158
    v_cvt_pk_bf16_f32 v119, v155, v159
    buffer_store_dword v116, v29, s[28:31], s44 offen offset:64
    buffer_store_dword v117, v29, s[28:31], s45 offen offset:64
    buffer_store_dword v118, v29, s[28:31], s46 offen offset:64
    buffer_store_dword v119, v29, s[28:31], s47 offen offset:64
    s_cmp_lg_u32 s36, 0
    s_cbranch_scc1 L_k1_nozero
    s_lshl_b32 s44, s2, 7
    s_add_u32 s44, s44, 6160384
    v_mov_b32 v2, 0
    v_lshlrev_b32 v3, 2, v1
    s_mov_b32 exec_hi, 0
    buffer_store_dword v2, v3, s[28:31], s44 offen
    s_mov_b32 exec_hi, -1
L_k1_nozero:
    s_branch L_k1_end
L_k1_cjob:
    s_getpc_b64 s[68:69]
L_k1_pc2:
    s_add_u32 s68, s68, fnet_k1_kernel-L_k1_pc2
    s_addc_u32 s69, s69, -1
    s_and_b32 s69, s69, 0xffff
    s_mov_b32 s70, L_code_end-fnet_k1_kernel
    s_mov_b32 s71, 0x20000
    v_lshlrev_b32 v2, 6, v0
    s_mov_b32 s39, 16384
    buffer_load_dword v216, v2, s[68:71], 0 offen
    buffer_load_dword v217, v2, s[68:71], s39 offen
    s_waitcnt vmcnt(0)
    s_sub_u32 s40, s2, 224
    s_mov_b32 s24, s20
    s_mov_b32 s25, s21
    s_mov_b32 s26, 1605632
    s_mov_b32 s27, 0x20000
    v_lshrrev_b32 v2, 3, v1
    v_mul_u32_u24 v2, 3584, v2
    v_and_b32 v3, 7, v1
    v_lshl_add_u32 v2, v3, 4, v2
    s_mul_i32 s41, s36, 401408
    s_lshl_b32 s42, s40, 7
    s_add_u32 s41, s41, s42
    v_mov_b32 v4, 0x3f80
    v_mov_b32 v5, 0x3f800000
    buffer_load_dwordx4 v[32:35], v2, s[24:27], s41 offen
    s_add_u32 s41, s41, 28672
    buffer_load_dwordx4 v[36:39], v2, s[24:27], s41 offen
    s_add_u32 s41, s41, 28672
    buffer_load_dwordx4 v[40:43], v2, s[24:27], s41 offen
    s_add_u32 s41, s41, 28672
    buffer_load_dwordx4 v[44:47], v2, s[24:27], s41 offen
    s_add_u32 s41, s41, 28672
    buffer_load_dwordx4 v[48:51], v2, s[24:27], s41 offen
    s_add_u32 s41, s41, 28672
    buffer_load_dwordx4 v[52:55], v2, s[24:27], s41 offen
    s_add_u32 s41, s41, 28672
    buffer_load_dwordx4 v[56:59], v2, s[24:27], s41 offen
    s_add_u32 s41, s41, 28672
    buffer_load_dwordx4 v[60:63], v2, s[24:27], s41 offen
    s_add_u32 s41, s41, 28672
    buffer_load_dwordx4 v[64:67], v2, s[24:27], s41 offen
    s_add_u32 s41, s41, 28672
    buffer_load_dwordx4 v[68:71], v2, s[24:27], s41 offen
    s_add_u32 s41, s41, 28672
    buffer_load_dwordx4 v[72:75], v2, s[24:27], s41 offen
    s_add_u32 s41, s41, 28672
    buffer_load_dwordx4 v[76:79], v2, s[24:27], s41 offen
    s_add_u32 s41, s41, 28672
    buffer_load_dwordx4 v[80:83], v2, s[24:27], s41 offen
    s_add_u32 s41, s41, 28672
    buffer_load_dwordx4 v[84:87], v2, s[24:27], s41 offen
    v_mov_b32 v128, 0
    v_mov_b32 v129, 0
    v_mov_b32 v130, 0
    v_mov_b32 v131, 0
    v_mov_b32 v132, 0
    v_mov_b32 v133, 0
    v_mov_b32 v134, 0
    v_mov_b32 v135, 0
    s_waitcnt vmcnt(13)
    v_dot2c_f32_bf16 v128, v32, v4
    v_dot2c_f32_bf16 v129, v32, v5
    v_dot2c_f32_bf16 v130, v33, v4
    v_dot2c_f32_bf16 v131, v33, v5
    v_dot2c_f32_bf16 v132, v34, v4
    v_dot2c_f32_bf16 v133, v34, v5
    v_dot2c_f32_bf16 v134, v35, v4
    v_dot2c_f32_bf16 v135, v35, v5
    s_waitcnt vmcnt(12)
    v_dot2c_f32_bf16 v128, v36, v4
    v_dot2c_f32_bf16 v129, v36, v5
    v_dot2c_f32_bf16 v130, v37, v4
    v_dot2c_f32_bf16 v131, v37, v5
    v_dot2c_f32_bf16 v132, v38, v4
    v_dot2c_f32_bf16 v133, v38, v5
    v_dot2c_f32_bf16 v134, v39, v4
    v_dot2c_f32_bf16 v135, v39, v5
    s_waitcnt vmcnt(11)
    v_dot2c_f32_bf16 v128, v40, v4
    v_dot2c_f32_bf16 v129, v40, v5
    v_dot2c_f32_bf16 v130, v41, v4
    v_dot2c_f32_bf16 v131, v41, v5
    v_dot2c_f32_bf16 v132, v42, v4
    v_dot2c_f32_bf16 v133, v42, v5
    v_dot2c_f32_bf16 v134, v43, v4
    v_dot2c_f32_bf16 v135, v43, v5
    s_waitcnt vmcnt(10)
    v_dot2c_f32_bf16 v128, v44, v4
    v_dot2c_f32_bf16 v129, v44, v5
    v_dot2c_f32_bf16 v130, v45, v4
    v_dot2c_f32_bf16 v131, v45, v5
    v_dot2c_f32_bf16 v132, v46, v4
    v_dot2c_f32_bf16 v133, v46, v5
    v_dot2c_f32_bf16 v134, v47, v4
    v_dot2c_f32_bf16 v135, v47, v5
    s_waitcnt vmcnt(9)
    v_dot2c_f32_bf16 v128, v48, v4
    v_dot2c_f32_bf16 v129, v48, v5
    v_dot2c_f32_bf16 v130, v49, v4
    v_dot2c_f32_bf16 v131, v49, v5
    v_dot2c_f32_bf16 v132, v50, v4
    v_dot2c_f32_bf16 v133, v50, v5
    v_dot2c_f32_bf16 v134, v51, v4
    v_dot2c_f32_bf16 v135, v51, v5
    s_waitcnt vmcnt(8)
    v_dot2c_f32_bf16 v128, v52, v4
    v_dot2c_f32_bf16 v129, v52, v5
    v_dot2c_f32_bf16 v130, v53, v4
    v_dot2c_f32_bf16 v131, v53, v5
    v_dot2c_f32_bf16 v132, v54, v4
    v_dot2c_f32_bf16 v133, v54, v5
    v_dot2c_f32_bf16 v134, v55, v4
    v_dot2c_f32_bf16 v135, v55, v5
    s_waitcnt vmcnt(7)
    v_dot2c_f32_bf16 v128, v56, v4
    v_dot2c_f32_bf16 v129, v56, v5
    v_dot2c_f32_bf16 v130, v57, v4
    v_dot2c_f32_bf16 v131, v57, v5
    v_dot2c_f32_bf16 v132, v58, v4
    v_dot2c_f32_bf16 v133, v58, v5
    v_dot2c_f32_bf16 v134, v59, v4
    v_dot2c_f32_bf16 v135, v59, v5
    s_waitcnt vmcnt(6)
    v_dot2c_f32_bf16 v128, v60, v4
    v_dot2c_f32_bf16 v129, v60, v5
    v_dot2c_f32_bf16 v130, v61, v4
    v_dot2c_f32_bf16 v131, v61, v5
    v_dot2c_f32_bf16 v132, v62, v4
    v_dot2c_f32_bf16 v133, v62, v5
    v_dot2c_f32_bf16 v134, v63, v4
    v_dot2c_f32_bf16 v135, v63, v5
    s_waitcnt vmcnt(5)
    v_dot2c_f32_bf16 v128, v64, v4
    v_dot2c_f32_bf16 v129, v64, v5
    v_dot2c_f32_bf16 v130, v65, v4
    v_dot2c_f32_bf16 v131, v65, v5
    v_dot2c_f32_bf16 v132, v66, v4
    v_dot2c_f32_bf16 v133, v66, v5
    v_dot2c_f32_bf16 v134, v67, v4
    v_dot2c_f32_bf16 v135, v67, v5
    s_waitcnt vmcnt(4)
    v_dot2c_f32_bf16 v128, v68, v4
    v_dot2c_f32_bf16 v129, v68, v5
    v_dot2c_f32_bf16 v130, v69, v4
    v_dot2c_f32_bf16 v131, v69, v5
    v_dot2c_f32_bf16 v132, v70, v4
    v_dot2c_f32_bf16 v133, v70, v5
    v_dot2c_f32_bf16 v134, v71, v4
    v_dot2c_f32_bf16 v135, v71, v5
    s_waitcnt vmcnt(3)
    v_dot2c_f32_bf16 v128, v72, v4
    v_dot2c_f32_bf16 v129, v72, v5
    v_dot2c_f32_bf16 v130, v73, v4
    v_dot2c_f32_bf16 v131, v73, v5
    v_dot2c_f32_bf16 v132, v74, v4
    v_dot2c_f32_bf16 v133, v74, v5
    v_dot2c_f32_bf16 v134, v75, v4
    v_dot2c_f32_bf16 v135, v75, v5
    s_waitcnt vmcnt(2)
    v_dot2c_f32_bf16 v128, v76, v4
    v_dot2c_f32_bf16 v129, v76, v5
    v_dot2c_f32_bf16 v130, v77, v4
    v_dot2c_f32_bf16 v131, v77, v5
    v_dot2c_f32_bf16 v132, v78, v4
    v_dot2c_f32_bf16 v133, v78, v5
    v_dot2c_f32_bf16 v134, v79, v4
    v_dot2c_f32_bf16 v135, v79, v5
    s_waitcnt vmcnt(1)
    v_dot2c_f32_bf16 v128, v80, v4
    v_dot2c_f32_bf16 v129, v80, v5
    v_dot2c_f32_bf16 v130, v81, v4
    v_dot2c_f32_bf16 v131, v81, v5
    v_dot2c_f32_bf16 v132, v82, v4
    v_dot2c_f32_bf16 v133, v82, v5
    v_dot2c_f32_bf16 v134, v83, v4
    v_dot2c_f32_bf16 v135, v83, v5
    s_waitcnt vmcnt(0)
    v_dot2c_f32_bf16 v128, v84, v4
    v_dot2c_f32_bf16 v129, v84, v5
    v_dot2c_f32_bf16 v130, v85, v4
    v_dot2c_f32_bf16 v131, v85, v5
    v_dot2c_f32_bf16 v132, v86, v4
    v_dot2c_f32_bf16 v133, v86, v5
    v_dot2c_f32_bf16 v134, v87, v4
    v_dot2c_f32_bf16 v135, v87, v5
    v_lshrrev_b32 v2, 3, v1
    s_lshl_b32 s41, s36, 3
    v_add_u32 v2, s41, v2
    v_lshlrev_b32 v2, 8, v2
    v_lshl_add_u32 v2, v3, 5, v2
    ds_write_b128 v2, v[128:131]
    ds_write_b128 v2, v[132:135] offset:16
    s_waitcnt lgkmcnt(0)
    s_barrier
    s_cmp_lg_u32 s36, 0
    s_cbranch_scc1 L_k1_end
    v_lshlrev_b32 v2, 2, v1
    ds_read_b32 v32, v2 offset:0
    ds_read_b32 v33, v2 offset:256
    ds_read_b32 v34, v2 offset:512
    ds_read_b32 v35, v2 offset:768
    ds_read_b32 v36, v2 offset:1024
    ds_read_b32 v37, v2 offset:1280
    ds_read_b32 v38, v2 offset:1536
    ds_read_b32 v39, v2 offset:1792
    ds_read_b32 v40, v2 offset:2048
    ds_read_b32 v41, v2 offset:2304
    ds_read_b32 v42, v2 offset:2560
    ds_read_b32 v43, v2 offset:2816
    ds_read_b32 v44, v2 offset:3072
    ds_read_b32 v45, v2 offset:3328
    ds_read_b32 v46, v2 offset:3584
    ds_read_b32 v47, v2 offset:3840
    s_waitcnt lgkmcnt(0)
    ds_read_b32 v48, v2 offset:4096
    ds_read_b32 v49, v2 offset:4352
    ds_read_b32 v50, v2 offset:4608
    ds_read_b32 v51, v2 offset:4864
    ds_read_b32 v52, v2 offset:5120
    ds_read_b32 v53, v2 offset:5376
    ds_read_b32 v54, v2 offset:5632
    ds_read_b32 v55, v2 offset:5888
    ds_read_b32 v56, v2 offset:6144
    ds_read_b32 v57, v2 offset:6400
    ds_read_b32 v58, v2 offset:6656
    ds_read_b32 v59, v2 offset:6912
    ds_read_b32 v60, v2 offset:7168
    ds_read_b32 v61, v2 offset:7424
    ds_read_b32 v62, v2 offset:7680
    ds_read_b32 v63, v2 offset:7936
    s_waitcnt lgkmcnt(0)
    v_add_f32 v32, v32, v33
    v_add_f32 v32, v32, v34
    v_add_f32 v32, v32, v35
    v_add_f32 v32, v32, v36
    v_add_f32 v32, v32, v37
    v_add_f32 v32, v32, v38
    v_add_f32 v32, v32, v39
    v_add_f32 v32, v32, v40
    v_add_f32 v32, v32, v41
    v_add_f32 v32, v32, v42
    v_add_f32 v32, v32, v43
    v_add_f32 v32, v32, v44
    v_add_f32 v32, v32, v45
    v_add_f32 v32, v32, v46
    v_add_f32 v32, v32, v47
    v_add_f32 v32, v32, v48
    v_add_f32 v32, v32, v49
    v_add_f32 v32, v32, v50
    v_add_f32 v32, v32, v51
    v_add_f32 v32, v32, v52
    v_add_f32 v32, v32, v53
    v_add_f32 v32, v32, v54
    v_add_f32 v32, v32, v55
    v_add_f32 v32, v32, v56
    v_add_f32 v32, v32, v57
    v_add_f32 v32, v32, v58
    v_add_f32 v32, v32, v59
    v_add_f32 v32, v32, v60
    v_add_f32 v32, v32, v61
    v_add_f32 v32, v32, v62
    v_add_f32 v32, v32, v63
    s_lshl_b32 s41, s40, 6
    v_add_u32 v3, s41, v1
    v_lshrrev_b32 v4, 7, v3
    v_lshlrev_b32 v4, 2, v4
    v_and_b32 v5, 3, v3
    v_add_u32 v4, v4, v5
    v_lshlrev_b32 v4, 5, v4
    v_bfe_u32 v5, v3, 2, 5
    v_add_u32 v4, v4, v5
    v_lshlrev_b32 v4, 2, v4
    s_mov_b32 s41, 6029312
    buffer_store_dword v32, v4, s[28:31], s41 offen
L_k1_end:
    s_endpgm

.globl fnet_k2_kernel
.p2align 8
.type fnet_k2_kernel,@function
fnet_k2_kernel:
    s_cmp_ge_u32 s2, 224
    s_cbranch_scc1 L_k2_end
    s_load_dwordx2 s[8:9], s[0:1], 80
    s_load_dwordx2 s[12:13], s[0:1], 0
    s_load_dwordx2 s[16:17], s[0:1], 64
    s_and_b32 s45, s2, 7
    s_lshr_b32 s46, s2, 3
    s_mul_i32 s47, s46, 37
    s_lshr_b32 s47, s47, 8
    s_mul_i32 s48, s47, 7
    s_sub_u32 s40, s46, s48
    s_lshl_b32 s45, s45, 2
    s_add_u32 s39, s45, s47
    v_and_b32 v1, 63, v0
    v_lshrrev_b32 v2, 6, v0
    v_lshlrev_b32 v10, 4, v1
    v_readfirstlane_b32 s36, v2
    s_mov_b32 s41, s39
    s_sub_u32 s42, 64, s39
    s_cmp_eq_u32 s39, 0
    s_cselect_b32 s42, 32, s42
    s_and_b32 s37, s36, 1
    s_lshr_b32 s38, s36, 1
    v_lshrrev_b32 v2, 3, v1
    v_and_b32 v3, 7, v1
    v_lshrrev_b32 v4, 1, v2
    v_xor_b32 v3, v3, v4
    v_lshlrev_b32 v3, 4, v3
    v_mul_u32_u24 v4, 57344, v2
    v_add_u32 v11, v4, v3
    v_xor_b32 v12, 64, v11
    s_cmp_ge_u32 s36, 2
    s_cselect_b32 s45, s42, s41
    s_lshl_b32 s46, s45, 5
    s_lshl_b32 s47, s37, 4
    s_add_u32 s46, s46, s47
    s_mul_i32 s46, s46, 896
    s_lshl_b32 s47, s36, 14
    s_add_u32 s47, s47, 57600
    s_and_b32 s53, s40, 3
    s_lshl_b32 s48, s37, 10
    s_add_u32 s48, s48, s45
    s_mul_i32 s48, s48, 896
    s_add_u32 s49, s48, 458752
    s_lshl_b32 s50, s36, 11
    s_lshl_b32 s58, s53, 1
    s_waitcnt lgkmcnt(0)
    s_mov_b32 s10, 21233664
    s_mov_b32 s11, 0x20000
    s_mov_b32 s14, 1835008
    s_mov_b32 s15, 0x20000
    s_mov_b32 s18, 1835008
    s_mov_b32 s19, 0x20000
    v_cmp_gt_u32 vcc, 56, v1
    v_mov_b32 v2, 0x7ff00000
s_nop 0
    v_cndmask_b32 v9, v2, v10, vcc
    s_xor_b32 s54, s53, 0
    s_mul_i32 s55, s54, 3584
    s_add_u32 s55, s55, s46
    s_lshl_b32 s56, s54, 12
    s_add_u32 s56, s56, s47
    s_add_u32 m0, s56, 0
    s_add_u32 s51, s55, 0
    buffer_load_dwordx4 v9, s[8:11], s51 offen lds
    s_add_u32 m0, s56, 1024
    s_add_u32 s51, s55, 896
    buffer_load_dwordx4 v9, s[8:11], s51 offen lds
    s_add_u32 m0, s56, 2048
    s_add_u32 s51, s55, 1792
    buffer_load_dwordx4 v9, s[8:11], s51 offen lds
    s_add_u32 m0, s56, 3072
    s_add_u32 s51, s55, 2688
    buffer_load_dwordx4 v9, s[8:11], s51 offen lds
    s_add_u32 m0, s50, 0
    s_nop 0
    buffer_load_dwordx4 v11, s[12:15], s48 offen offset:0 lds
    s_add_u32 m0, s50, 1024
    s_nop 0
    buffer_load_dwordx4 v12, s[12:15], s49 offen offset:0 lds
    s_xor_b32 s54, s53, 1
    s_mul_i32 s55, s54, 3584
    s_add_u32 s55, s55, s46
    s_lshl_b32 s56, s54, 12
    s_add_u32 s56, s56, s47
    s_add_u32 m0, s56, 0
    s_add_u32 s51, s55, 0
    buffer_load_dwordx4 v9, s[8:11], s51 offen lds
    s_add_u32 m0, s56, 1024
    s_add_u32 s51, s55, 896
    buffer_load_dwordx4 v9, s[8:11], s51 offen lds
    v_and_b32 v2, 31, v1
    v_lshrrev_b32 v30, 5, v1
    v_mov_b32 v27, 0
    v_mov_b32 v28, 0
    v_mov_b32 v29, 0
    v_mov_b32 v31, 0
    v_lshlrev_b32 v3, 10, v1
    v_add_u32 v3, 57596, v3
    s_add_u32 m0, s56, 2048
    s_add_u32 s51, s55, 1792
    buffer_load_dwordx4 v9, s[8:11], s51 offen lds
    v_mov_b32 v4, 0
    ds_write_b32 v3, v4
    v_lshrrev_b32 v3, 3, v2
    v_lshlrev_b32 v3, 10, v3
    v_and_b32 v4, 7, v2
    v_lshl_add_u32 v3, v4, 7, v3
    s_lshl_b32 s45, s37, 12
    v_add_u32 v3, s45, v3
    s_add_u32 m0, s56, 3072
    s_add_u32 s51, s55, 2688
    buffer_load_dwordx4 v9, s[8:11], s51 offen lds
    v_bfe_u32 v4, v2, 1, 3
    v_xor_b32 v5, v4, v30
    v_lshl_add_u32 v15, v5, 4, v3
    v_xor_b32 v16, 32, v15
    v_xor_b32 v17, 64, v15
    v_xor_b32 v18, 96, v15
    v_lshl_add_u32 v5, v4, 4, v3
    v_lshl_add_u32 v19, v30, 3, v5
    s_add_u32 m0, s50, 24192
    s_nop 0
    buffer_load_dwordx4 v11, s[12:15], s48 offen offset:384 lds
    v_xor_b32 v20, 16, v19
    v_xor_b32 v21, 32, v19
    v_xor_b32 v22, 48, v19
    v_xor_b32 v23, 64, v19
    v_xor_b32 v24, 80, v19
    v_xor_b32 v25, 96, v19
    v_xor_b32 v26, 112, v19
    s_xor_b32 s45, s37, 1
    s_add_u32 m0, s50, 25216
    s_nop 0
    buffer_load_dwordx4 v12, s[12:15], s49 offen offset:384 lds
    s_cmp_eq_u32 s39, 0
    s_cselect_b32 s45, s37, s45
    s_cmp_eq_u32 s38, 0
    s_cselect_b32 s45, s37, s45
    s_lshl_b32 s45, s45, 15
    s_add_u32 s45, s45, 57600
    v_lshlrev_b32 v3, 12, v30
    v_add_u32 v3, s45, v3
    s_xor_b32 s54, s53, 2
    s_mul_i32 s55, s54, 3584
    s_add_u32 s55, s55, s46
    s_lshl_b32 s56, s54, 12
    s_add_u32 s56, s56, s47
    s_add_u32 m0, s56, 0
    s_add_u32 s51, s55, 0
    buffer_load_dwordx4 v9, s[8:11], s51 offen lds
    v_sub_u32 v4, 31, v2
    v_subrev_u32 v5, 1, v2
    s_cmp_eq_u32 s38, 0
    s_cselect_b64 s[100:101], -1, 0
    v_cndmask_b32 v4, v4, v5, s[100:101]
    v_lshl_add_u32 v13, v4, 2, v3
    v_add_u32 v14, 128, v13
    s_cmp_eq_u32 s37, 0
    s_cselect_b32 s45, s41, s42
    v_lshl_add_u32 v3, v2, 6, s45
    s_add_u32 m0, s56, 1024
    s_add_u32 s51, s55, 896
    buffer_load_dwordx4 v9, s[8:11], s51 offen lds
    v_cvt_f32_u32 v3, v3
    s_lshl_b32 s45, s38, 31
    s_xor_b32 s45, s45, 0x3a000000
    v_mul_f32 v3, s45, v3
    v_lshlrev_b32 v4, 2, v30
    v_cvt_f32_u32 v4, v4
    v_mul_f32 v4, v3, v4
    v_fmamk_f32 v5, v3, 0x00000000, v4
    s_add_u32 m0, s56, 2048
    s_add_u32 s51, s55, 1792
    buffer_load_dwordx4 v9, s[8:11], s51 offen lds
    v_cos_f32 v6, v5
    v_sin_f32 v7, v5
s_nop 0
    v_cvt_pk_bf16_f32 v96, v6, v7
    v_fmamk_f32 v5, v3, 0x3f800000, v4
    v_cos_f32 v6, v5
    v_sin_f32 v7, v5
s_nop 0
    v_cvt_pk_bf16_f32 v97, v6, v7
    v_fmamk_f32 v5, v3, 0x40000000, v4
    s_add_u32 m0, s56, 3072
    s_add_u32 s51, s55, 2688
    buffer_load_dwordx4 v9, s[8:11], s51 offen lds
    v_cos_f32 v6, v5
    v_sin_f32 v7, v5
s_nop 0
    v_cvt_pk_bf16_f32 v98, v6, v7
    v_fmamk_f32 v5, v3, 0x40400000, v4
    v_cos_f32 v6, v5
    v_sin_f32 v7, v5
s_nop 0
    v_cvt_pk_bf16_f32 v99, v6, v7
    v_fmamk_f32 v5, v3, 0x41000000, v4
    s_xor_b32 s54, s53, 3
    s_mul_i32 s55, s54, 3584
    s_add_u32 s55, s55, s46
    s_lshl_b32 s56, s54, 12
    s_add_u32 s56, s56, s47
    s_add_u32 m0, s56, 0
    s_add_u32 s51, s55, 0
    buffer_load_dwordx4 v9, s[8:11], s51 offen lds
    v_cos_f32 v6, v5
    v_sin_f32 v7, v5
s_nop 0
    v_cvt_pk_bf16_f32 v100, v6, v7
    v_fmamk_f32 v5, v3, 0x41100000, v4
    v_cos_f32 v6, v5
    v_sin_f32 v7, v5
s_nop 0
    v_cvt_pk_bf16_f32 v101, v6, v7
    v_fmamk_f32 v5, v3, 0x41200000, v4
    s_add_u32 m0, s56, 1024
    s_add_u32 s51, s55, 896
    buffer_load_dwordx4 v9, s[8:11], s51 offen lds
    v_cos_f32 v6, v5
    v_sin_f32 v7, v5
s_nop 0
    v_cvt_pk_bf16_f32 v102, v6, v7
    v_fmamk_f32 v5, v3, 0x41300000, v4
    v_cos_f32 v6, v5
    v_sin_f32 v7, v5
s_nop 0
    v_cvt_pk_bf16_f32 v103, v6, v7
    v_fmamk_f32 v5, v3, 0x41800000, v4
    s_add_u32 m0, s56, 2048
    s_add_u32 s51, s55, 1792
    buffer_load_dwordx4 v9, s[8:11], s51 offen lds
    v_cos_f32 v6, v5
    v_sin_f32 v7, v5
s_nop 0
    v_cvt_pk_bf16_f32 v104, v6, v7
    v_fmamk_f32 v5, v3, 0x41880000, v4
    v_cos_f32 v6, v5
    v_sin_f32 v7, v5
s_nop 0
    v_cvt_pk_bf16_f32 v105, v6, v7
    v_fmamk_f32 v5, v3, 0x41900000, v4
    s_add_u32 m0, s56, 3072
    s_add_u32 s51, s55, 2688
    buffer_load_dwordx4 v9, s[8:11], s51 offen lds
    v_cos_f32 v6, v5
    v_sin_f32 v7, v5
s_nop 0
    v_cvt_pk_bf16_f32 v106, v6, v7
    v_fmamk_f32 v5, v3, 0x41980000, v4
    v_cos_f32 v6, v5
    v_sin_f32 v7, v5
s_nop 0
    v_cvt_pk_bf16_f32 v107, v6, v7
    v_fmamk_f32 v5, v3, 0x41c00000, v4
    s_add_u32 m0, s50, 32256
    s_nop 0
    buffer_load_dwordx4 v11, s[12:15], s48 offen offset:512 lds
    v_cos_f32 v6, v5
    v_sin_f32 v7, v5
s_nop 0
    v_cvt_pk_bf16_f32 v108, v6, v7
    v_fmamk_f32 v5, v3, 0x41c80000, v4
    v_cos_f32 v6, v5
    v_sin_f32 v7, v5
s_nop 0
    v_cvt_pk_bf16_f32 v109, v6, v7
    v_fmamk_f32 v5, v3, 0x41d00000, v4
    s_add_u32 m0, s50, 33280
    s_nop 0
    buffer_load_dwordx4 v12, s[12:15], s49 offen offset:512 lds
    v_cos_f32 v6, v5
    v_sin_f32 v7, v5
s_nop 0
    v_cvt_pk_bf16_f32 v110, v6, v7
    v_fmamk_f32 v5, v3, 0x41d80000, v4
    v_cos_f32 v6, v5
    v_sin_f32 v7, v5
s_nop 0
    v_cvt_pk_bf16_f32 v111, v6, v7
    v_and_b32 v5, 1, v2
    s_add_u32 m0, s50, 8064
    s_nop 0
    buffer_load_dwordx4 v11, s[12:15], s48 offen offset:128 lds
    v_lshlrev_b32 v5, 4, v5
    v_mov_b32 v6, 0x3f80
    v_lshlrev_b32 v5, v5, v6
    v_lshlrev_b32 v6, 3, v30
    v_sub_u32 v6, v2, v6
    v_ashrrev_i32 v7, 1, v6
    v_subrev_u32 v6, 16, v6
    v_ashrrev_i32 v8, 1, v6
    s_add_u32 m0, s50, 9088
    s_nop 0
    buffer_load_dwordx4 v12, s[12:15], s49 offen offset:128 lds
    v_cmp_eq_u32 s[70:71], 0, v7
    v_cmp_eq_u32 s[72:73], 1, v7
    v_cmp_eq_u32 s[74:75], 2, v7
    v_cmp_eq_u32 s[76:77], 3, v7
    v_cmp_eq_u32 s[78:79], 0, v8
    v_cmp_eq_u32 s[80:81], 1, v8
    v_cmp_eq_u32 s[82:83], 2, v8
    v_cmp_eq_u32 s[84:85], 3, v8
    v_cndmask_b32 v112, 0, v5, s[70:71]
    s_add_u32 m0, s50, 40320
    s_nop 0
    buffer_load_dwordx4 v11, s[12:15], s48 offen offset:640 lds
    v_cndmask_b32 v113, 0, v5, s[72:73]
    v_cndmask_b32 v114, 0, v5, s[74:75]
    v_cndmask_b32 v115, 0, v5, s[76:77]
    v_cndmask_b32 v116, 0, v5, s[78:79]
    v_cndmask_b32 v117, 0, v5, s[80:81]
    v_cndmask_b32 v118, 0, v5, s[82:83]
    v_cndmask_b32 v119, 0, v5, s[84:85]
    s_add_u32 m0, s50, 41344
    s_nop 0
    buffer_load_dwordx4 v12, s[12:15], s49 offen offset:640 lds
    s_add_u32 m0, s50, 16128
    s_nop 0
    buffer_load_dwordx4 v11, s[12:15], s48 offen offset:256 lds
    s_add_u32 m0, s50, 17152
    s_nop 0
    buffer_load_dwordx4 v12, s[12:15], s49 offen offset:256 lds
    s_add_u32 m0, s50, 48384
    s_nop 0
    buffer_load_dwordx4 v11, s[12:15], s48 offen offset:768 lds
    s_add_u32 m0, s50, 49408
    s_nop 0
    buffer_load_dwordx4 v12, s[12:15], s49 offen offset:768 lds
    s_lshl_b32 s45, s40, 2
    s_add_u32 s45, s45, s36
    s_lshl_b32 s46, s45, 8
    s_add_u32 s46, s46, 6029312
    v_and_b32 v2, 31, v1
    v_lshlrev_b32 v3, 2, v2
    buffer_load_dword v216, v3, s[8:11], s46 offen
    buffer_load_dword v217, v3, s[8:11], s46 offen offset:128
    s_mul_i32 s26, s45, 57344
    s_add_u32 s52, s26, 4194304
    s_add_u32 s26, s26, 2097152
    s_mov_b32 s24, 0
    s_lshl_b32 s25, s24, 12
    s_lshl_b32 s27, s24, 13
    s_lshl_b32 s28, s24, 13
    v_mov_b32 v220, 0x3f803f80
    v_mov_b32 v221, 0x3f803f80
    v_mov_b32 v222, 0x3f803f80
    v_mov_b32 v223, 0x3f803f80
    s_waitcnt vmcnt(10) lgkmcnt(0)
    s_barrier
    s_cmp_eq_u32 s38, 0
    s_cbranch_scc0 L_k2_sideR
    ds_read_b128 v[152:155], v15 offset:0
    ds_read_b128 v[156:159], v16 offset:0
    ds_read2st64_b32 v[120:121], v13 offset0:0 offset1:4
    ds_read2st64_b32 v[122:123], v13 offset0:8 offset1:12
    ds_read2st64_b32 v[124:125], v13 offset0:32 offset1:36
    ds_read2st64_b32 v[126:127], v13 offset0:40 offset1:44
    ds_read2st64_b32 v[128:129], v13 offset0:64 offset1:68
    ds_read2st64_b32 v[130:131], v13 offset0:72 offset1:76
    ds_read2st64_b32 v[132:133], v13 offset0:96 offset1:100
    ds_read2st64_b32 v[134:135], v13 offset0:104 offset1:108
    s_waitcnt lgkmcnt(8)
    v_mfma_f32_32x32x16_bf16 v[168:183], v[112:115], v[152:155], 0
    ds_read_b128 v[160:163], v17 offset:0
    ds_read_b128 v[164:167], v18 offset:0
    s_mov_b32 s43, s26
    buffer_load_dwordx4 a[0:3], v10, s[8:11], s43 offen offset:0
    v_mfma_f32_32x32x16_bf16 v[168:183], v[116:119], v[156:159], v[168:183]
    ds_read2st64_b32 v[136:137], v14 offset0:0 offset1:4
    ds_read2st64_b32 v[138:139], v14 offset0:8 offset1:12
    buffer_load_dwordx4 a[4:7], v10, s[8:11], s43 offen offset:1024
    s_waitcnt lgkmcnt(8)
    v_mfma_f32_32x32x16_bf16 v[168:183], v[120:123], v[96:99], v[168:183]
    ds_read2st64_b32 v[140:141], v14 offset0:32 offset1:36
    ds_read2st64_b32 v[142:143], v14 offset0:40 offset1:44
    v_mfma_f32_32x32x16_bf16 v[168:183], v[124:127], v[100:103], v[168:183]
    ds_read2st64_b32 v[144:145], v14 offset0:64 offset1:68
    ds_read2st64_b32 v[146:147], v14 offset0:72 offset1:76
    buffer_load_dwordx4 a[8:11], v10, s[8:11], s43 offen offset:2048
    s_waitcnt lgkmcnt(8)
    v_mfma_f32_32x32x16_bf16 v[168:183], v[128:131], v[104:107], v[168:183]
    ds_read2st64_b32 v[148:149], v14 offset0:96 offset1:100
    v_mfma_f32_32x32x16_bf16 v[168:183], v[132:135], v[108:111], v[168:183]
    ds_read2st64_b32 v[150:151], v14 offset0:104 offset1:108
    buffer_load_dwordx4 a[12:15], v10, s[8:11], s43 offen offset:3072
    s_add_u32 s43, s43, 4096
    s_waitcnt vmcnt(10)
    s_barrier
    s_waitcnt lgkmcnt(8)
    v_mfma_f32_32x32x16_bf16 v[184:199], v[112:115], v[160:163], 0
    ds_read_b128 v[152:155], v15 offset:8192
    ds_read_b128 v[156:159], v16 offset:8192
    buffer_load_dwordx4 a[16:19], v10, s[8:11], s43 offen offset:0
    v_mfma_f32_32x32x16_bf16 v[184:199], v[116:119], v[164:167], v[184:199]
s_nop 0
    v_cvt_pk_bf16_f32 v32, v168, v169
    v_cvt_pk_bf16_f32 v33, v170, v171
    ds_write_b64 v19, v[32:33] offset:0
    ds_read2st64_b32 v[120:121], v13 offset0:1 offset1:5
    buffer_load_dwordx4 a[20:23], v10, s[8:11], s43 offen offset:1024
    s_waitcnt lgkmcnt(8)
    v_mfma_f32_32x32x16_bf16 v[184:199], v[136:139], v[96:99], v[184:199]
    ds_read2st64_b32 v[122:123], v13 offset0:9 offset1:13
    v_cvt_pk_bf16_f32 v34, v172, v173
    v_cvt_pk_bf16_f32 v35, v174, v175
    ds_write_b64 v20, v[34:35] offset:0
    v_mfma_f32_32x32x16_bf16 v[184:199], v[140:143], v[100:103], v[184:199]
    ds_read2st64_b32 v[124:125], v13 offset0:33 offset1:37
    buffer_load_dwordx4 a[24:27], v10, s[8:11], s43 offen offset:2048
    s_waitcnt lgkmcnt(7)
    v_mfma_f32_32x32x16_bf16 v[184:199], v[144:147], v[104:107], v[184:199]
    v_cvt_pk_bf16_f32 v36, v176, v177
    v_cvt_pk_bf16_f32 v37, v178, v179
    ds_write_b64 v21, v[36:37] offset:0
    ds_read2st64_b32 v[126:127], v13 offset0:41 offset1:45
    v_mfma_f32_32x32x16_bf16 v[184:199], v[148:151], v[108:111], v[184:199]
    ds_read2st64_b32 v[128:129], v13 offset0:65 offset1:69
    v_cvt_pk_bf16_f32 v38, v180, v181
    v_cvt_pk_bf16_f32 v39, v182, v183
    ds_write_b64 v22, v[38:39] offset:0
    buffer_load_dwordx4 a[28:31], v10, s[8:11], s43 offen offset:3072
    s_add_u32 s43, s43, 4096
    v_mfma_f32_32x32x16_bf16 v[224:239], v[220:223], v[32:35], 0
    ds_read2st64_b32 v[130:131], v13 offset0:73 offset1:77
    v_mfma_f32_32x32x16_bf16 v[224:239], v[220:223], v[36:39], v[224:239]
    ds_read2st64_b32 v[132:133], v13 offset0:97 offset1:101
    ds_read2st64_b32 v[134:135], v13 offset0:105 offset1:109
    buffer_load_dwordx4 a[32:35], v10, s[8:11], s43 offen offset:0
    s_waitcnt lgkmcnt(12)
    v_mfma_f32_32x32x16_bf16 v[168:183], v[112:115], v[152:155], 0
    ds_read_b128 v[160:163], v17 offset:8192
    ds_read_b128 v[164:167], v18 offset:8192
    buffer_load_dwordx4 a[36:39], v10, s[8:11], s43 offen offset:1024
    v_mfma_f32_32x32x16_bf16 v[168:183], v[116:119], v[156:159], v[168:183]
    v_cvt_pk_bf16_f32 v40, v184, v185
    v_cvt_pk_bf16_f32 v41, v186, v187
    ds_write_b64 v23, v[40:41] offset:0
    ds_read2st64_b32 v[136:137], v14 offset0:1 offset1:5
    buffer_load_dwordx4 a[40:43], v10, s[8:11], s43 offen offset:2048
    s_waitcnt lgkmcnt(9)
    v_mfma_f32_32x32x16_bf16 v[168:183], v[120:123], v[96:99], v[168:183]
    ds_read2st64_b32 v[138:139], v14 offset0:9 offset1:13
    v_cvt_pk_bf16_f32 v42, v188, v189
    v_cvt_pk_bf16_f32 v43, v190, v191
    ds_write_b64 v24, v[42:43] offset:0
    v_mfma_f32_32x32x16_bf16 v[168:183], v[124:127], v[100:103], v[168:183]
    ds_read2st64_b32 v[140:141], v14 offset0:33 offset1:37
    buffer_load_dwordx4 a[44:47], v10, s[8:11], s43 offen offset:3072
    s_add_u32 s43, s43, 4096
    s_waitcnt lgkmcnt(7)
    v_mfma_f32_32x32x16_bf16 v[168:183], v[128:131], v[104:107], v[168:183]
    v_cvt_pk_bf16_f32 v44, v192, v193
    v_cvt_pk_bf16_f32 v45, v194, v195
    ds_write_b64 v25, v[44:45] offset:0
    ds_read2st64_b32 v[142:143], v14 offset0:41 offset1:45
    v_mfma_f32_32x32x16_bf16 v[168:183], v[132:135], v[108:111], v[168:183]
    ds_read2st64_b32 v[144:145], v14 offset0:65 offset1:69
    v_cvt_pk_bf16_f32 v46, v196, v197
    v_cvt_pk_bf16_f32 v47, v198, v199
    ds_write_b64 v26, v[46:47] offset:0
    buffer_load_dwordx4 a[48:51], v10, s[8:11], s43 offen offset:0
    v_mfma_f32_32x32x16_bf16 v[224:239], v[220:223], v[40:43], v[224:239]
    ds_read2st64_b32 v[146:147], v14 offset0:73 offset1:77
    v_mfma_f32_32x32x16_bf16 v[224:239], v[220:223], v[44:47], v[224:239]
    ds_read2st64_b32 v[148:149], v14 offset0:97 offset1:101
    ds_read2st64_b32 v[150:151], v14 offset0:105 offset1:109
    buffer_load_dwordx4 a[52:55], v10, s[8:11], s43 offen offset:1024
    s_waitcnt vmcnt(16)
    s_barrier
    s_waitcnt lgkmcnt(12)
    v_mfma_f32_32x32x16_bf16 v[184:199], v[112:115], v[160:163], 0
    ds_read_b128 v[152:155], v15 offset:16384
    ds_read_b128 v[156:159], v16 offset:16384
    buffer_load_dwordx4 a[56:59], v10, s[8:11], s43 offen offset:2048
    v_mfma_f32_32x32x16_bf16 v[184:199], v[116:119], v[164:167], v[184:199]
    v_cvt_pk_bf16_f32 v48, v168, v169
    v_cvt_pk_bf16_f32 v49, v170, v171
    ds_write_b64 v19, v[48:49] offset:8192
    ds_read2st64_b32 v[120:121], v13 offset0:2 offset1:6
    buffer_load_dwordx4 a[60:63], v10, s[8:11], s43 offen offset:3072
    s_add_u32 s43, s43, 4096
    s_waitcnt lgkmcnt(9)
    v_mfma_f32_32x32x16_bf16 v[184:199], v[136:139], v[96:99], v[184:199]
    ds_read2st64_b32 v[122:123], v13 offset0:10 offset1:14
    v_cvt_pk_bf16_f32 v50, v172, v173
    v_cvt_pk_bf16_f32 v51, v174, v175
    ds_write_b64 v20, v[50:51] offset:8192
    v_mfma_f32_32x32x16_bf16 v[184:199], v[140:143], v[100:103], v[184:199]
    ds_read2st64_b32 v[124:125], v13 offset0:34 offset1:38
    buffer_load_dwordx4 a[64:67], v10, s[8:11], s43 offen offset:0
    s_waitcnt lgkmcnt(7)
    v_mfma_f32_32x32x16_bf16 v[184:199], v[144:147], v[104:107], v[184:199]
    v_cvt_pk_bf16_f32 v52, v176, v177
    v_cvt_pk_bf16_f32 v53, v178, v179
    ds_write_b64 v21, v[52:53] offset:8192
    ds_read2st64_b32 v[126:127], v13 offset0:42 offset1:46
    v_mfma_f32_32x32x16_bf16 v[184:199], v[148:151], v[108:111], v[184:199]
    ds_read2st64_b32 v[128:129], v13 offset0:66 offset1:70
    v_cvt_pk_bf16_f32 v54, v180, v181
    v_cvt_pk_bf16_f32 v55, v182, v183
    ds_write_b64 v22, v[54:55] offset:8192
    buffer_load_dwordx4 a[68:71], v10, s[8:11], s43 offen offset:1024
    v_mfma_f32_32x32x16_bf16 v[224:239], v[220:223], v[48:51], v[224:239]
    ds_read2st64_b32 v[130:131], v13 offset0:74 offset1:78
    v_mfma_f32_32x32x16_bf16 v[224:239], v[220:223], v[52:55], v[224:239]
    ds_read2st64_b32 v[132:133], v13 offset0:98 offset1:102
    ds_read2st64_b32 v[134:135], v13 offset0:106 offset1:110
    buffer_load_dwordx4 a[72:75], v10, s[8:11], s43 offen offset:2048
    s_waitcnt lgkmcnt(12)
    v_mfma_f32_32x32x16_bf16 v[168:183], v[112:115], v[152:155], 0
    ds_read_b128 v[160:163], v17 offset:16384
    ds_read_b128 v[164:167], v18 offset:16384
    buffer_load_dwordx4 a[76:79], v10, s[8:11], s43 offen offset:3072
    s_add_u32 s43, s43, 4096
    v_mfma_f32_32x32x16_bf16 v[168:183], v[116:119], v[156:159], v[168:183]
    v_cvt_pk_bf16_f32 v56, v184, v185
    v_cvt_pk_bf16_f32 v57, v186, v187
    ds_write_b64 v23, v[56:57] offset:8192
    ds_read2st64_b32 v[136:137], v14 offset0:2 offset1:6
    buffer_load_dwordx4 a[80:83], v10, s[8:11], s43 offen offset:0
    s_waitcnt lgkmcnt(9)
    v_mfma_f32_32x32x16_bf16 v[168:183], v[120:123], v[96:99], v[168:183]
    ds_read2st64_b32 v[138:139], v14 offset0:10 offset1:14
    v_cvt_pk_bf16_f32 v58, v188, v189
    v_cvt_pk_bf16_f32 v59, v190, v191
    ds_write_b64 v24, v[58:59] offset:8192
    v_mfma_f32_32x32x16_bf16 v[168:183], v[124:127], v[100:103], v[168:183]
    ds_read2st64_b32 v[140:141], v14 offset0:34 offset1:38
    buffer_load_dwordx4 a[84:87], v10, s[8:11], s43 offen offset:1024
    s_waitcnt lgkmcnt(7)
    v_mfma_f32_32x32x16_bf16 v[168:183], v[128:131], v[104:107], v[168:183]
    v_cvt_pk_bf16_f32 v60, v192, v193
    v_cvt_pk_bf16_f32 v61, v194, v195
    ds_write_b64 v25, v[60:61] offset:8192
    ds_read2st64_b32 v[142:143], v14 offset0:42 offset1:46
    v_mfma_f32_32x32x16_bf16 v[168:183], v[132:135], v[108:111], v[168:183]
    ds_read2st64_b32 v[144:145], v14 offset0:66 offset1:70
    v_cvt_pk_bf16_f32 v62, v196, v197
    v_cvt_pk_bf16_f32 v63, v198, v199
    ds_write_b64 v26, v[62:63] offset:8192
    buffer_load_dwordx4 a[88:91], v10, s[8:11], s43 offen offset:2048
    v_mfma_f32_32x32x16_bf16 v[224:239], v[220:223], v[56:59], v[224:239]
    ds_read2st64_b32 v[146:147], v14 offset0:74 offset1:78
    v_mfma_f32_32x32x16_bf16 v[224:239], v[220:223], v[60:63], v[224:239]
    ds_read2st64_b32 v[148:149], v14 offset0:98 offset1:102
    ds_read2st64_b32 v[150:151], v14 offset0:106 offset1:110
    buffer_load_dwordx4 a[92:95], v10, s[8:11], s43 offen offset:3072
    s_add_u32 s43, s43, 4096
    s_waitcnt lgkmcnt(12)
    v_mfma_f32_32x32x16_bf16 v[184:199], v[112:115], v[160:163], 0
    ds_read_b128 v[152:155], v15 offset:24576
    ds_read_b128 v[156:159], v16 offset:24576
    buffer_load_dwordx4 a[96:99], v10, s[8:11], s43 offen offset:0
    v_mfma_f32_32x32x16_bf16 v[184:199], v[116:119], v[164:167], v[184:199]
    v_cvt_pk_bf16_f32 v64, v168, v169
    v_cvt_pk_bf16_f32 v65, v170, v171
    ds_write_b64 v19, v[64:65] offset:16384
    ds_read2st64_b32 v[120:121], v13 offset0:3 offset1:7
    buffer_load_dwordx4 a[100:103], v10, s[8:11], s43 offen offset:1024
    s_waitcnt lgkmcnt(9)
    v_mfma_f32_32x32x16_bf16 v[184:199], v[136:139], v[96:99], v[184:199]
    ds_read2st64_b32 v[122:123], v13 offset0:11 offset1:15
    v_cvt_pk_bf16_f32 v66, v172, v173
    v_cvt_pk_bf16_f32 v67, v174, v175
    ds_write_b64 v20, v[66:67] offset:16384
    v_mfma_f32_32x32x16_bf16 v[184:199], v[140:143], v[100:103], v[184:199]
    ds_read2st64_b32 v[124:125], v13 offset0:35 offset1:39
    buffer_load_dwordx4 a[104:107], v10, s[8:11], s43 offen offset:2048
    s_waitcnt lgkmcnt(7)
    v_mfma_f32_32x32x16_bf16 v[184:199], v[144:147], v[104:107], v[184:199]
    v_cvt_pk_bf16_f32 v68, v176, v177
    v_cvt_pk_bf16_f32 v69, v178, v179
    ds_write_b64 v21, v[68:69] offset:16384
    ds_read2st64_b32 v[126:127], v13 offset0:43 offset1:47
    v_mfma_f32_32x32x16_bf16 v[184:199], v[148:151], v[108:111], v[184:199]
    ds_read2st64_b32 v[128:129], v13 offset0:67 offset1:71
    v_cvt_pk_bf16_f32 v70, v180, v181
    v_cvt_pk_bf16_f32 v71, v182, v183
    ds_write_b64 v22, v[70:71] offset:16384
    buffer_load_dwordx4 a[108:111], v10, s[8:11], s43 offen offset:3072
    s_add_u32 s43, s43, 4096
    v_mfma_f32_32x32x16_bf16 v[224:239], v[220:223], v[64:67], v[224:239]
    ds_read2st64_b32 v[130:131], v13 offset0:75 offset1:79
    v_mfma_f32_32x32x16_bf16 v[224:239], v[220:223], v[68:71], v[224:239]
    ds_read2st64_b32 v[132:133], v13 offset0:99 offset1:103
    ds_read2st64_b32 v[134:135], v13 offset0:107 offset1:111
    buffer_load_dwordx4 a[112:115], v10, s[8:11], s43 offen offset:0
    s_waitcnt lgkmcnt(12)
    v_mfma_f32_32x32x16_bf16 v[168:183], v[112:115], v[152:155], 0
    buffer_load_dwordx4 a[116:119], v10, s[8:11], s43 offen offset:1024
    v_mfma_f32_32x32x16_bf16 v[168:183], v[116:119], v[156:159], v[168:183]
    v_cvt_pk_bf16_f32 v72, v184, v185
    v_cvt_pk_bf16_f32 v73, v186, v187
    ds_write_b64 v23, v[72:73] offset:16384
    buffer_load_dwordx4 a[120:123], v10, s[8:11], s43 offen offset:2048
    s_waitcnt lgkmcnt(6)
    v_mfma_f32_32x32x16_bf16 v[168:183], v[120:123], v[96:99], v[168:183]
    v_cvt_pk_bf16_f32 v74, v188, v189
    v_cvt_pk_bf16_f32 v75, v190, v191
    ds_write_b64 v24, v[74:75] offset:16384
    v_mfma_f32_32x32x16_bf16 v[168:183], v[124:127], v[100:103], v[168:183]
    buffer_load_dwordx4 a[124:127], v10, s[8:11], s43 offen offset:3072
    s_add_u32 s43, s43, 4096
    s_waitcnt lgkmcnt(2)
    v_mfma_f32_32x32x16_bf16 v[168:183], v[128:131], v[104:107], v[168:183]
    v_cvt_pk_bf16_f32 v76, v192, v193
    v_cvt_pk_bf16_f32 v77, v194, v195
    ds_write_b64 v25, v[76:77] offset:16384
    v_mfma_f32_32x32x16_bf16 v[168:183], v[132:135], v[108:111], v[168:183]
    v_cvt_pk_bf16_f32 v78, v196, v197
    v_cvt_pk_bf16_f32 v79, v198, v199
    ds_write_b64 v26, v[78:79] offset:16384
    buffer_load_dwordx4 a[128:131], v10, s[8:11], s43 offen offset:0
    v_mfma_f32_32x32x16_bf16 v[224:239], v[220:223], v[72:75], v[224:239]
    v_mfma_f32_32x32x16_bf16 v[224:239], v[220:223], v[76:79], v[224:239]
    buffer_load_dwordx4 a[132:135], v10, s[8:11], s43 offen offset:1024
s_nop 4
    v_cvt_pk_bf16_f32 v80, v168, v169
    v_cvt_pk_bf16_f32 v81, v170, v171
    ds_write_b64 v19, v[80:81] offset:24576
    v_cvt_pk_bf16_f32 v82, v172, v173
    v_cvt_pk_bf16_f32 v83, v174, v175
    ds_write_b64 v20, v[82:83] offset:24576
    v_cvt_pk_bf16_f32 v84, v176, v177
    v_cvt_pk_bf16_f32 v85, v178, v179
    ds_write_b64 v21, v[84:85] offset:24576
    v_cvt_pk_bf16_f32 v86, v180, v181
    v_cvt_pk_bf16_f32 v87, v182, v183
    ds_write_b64 v22, v[86:87] offset:24576
    v_mfma_f32_32x32x16_bf16 v[224:239], v[220:223], v[80:83], v[224:239]
    v_mfma_f32_32x32x16_bf16 v[224:239], v[220:223], v[84:87], v[224:239]
    s_branch L_k2_p2done
L_k2_sideR:
    ds_read_b128 v[152:155], v17 offset:24576
    ds_read_b128 v[156:159], v18 offset:24576
    ds_read2st64_b32 v[120:121], v13 offset0:3 offset1:7
    ds_read2st64_b32 v[122:123], v13 offset0:11 offset1:15
    ds_read2st64_b32 v[124:125], v13 offset0:35 offset1:39
    ds_read2st64_b32 v[126:127], v13 offset0:43 offset1:47
    ds_read2st64_b32 v[128:129], v13 offset0:67 offset1:71
    ds_read2st64_b32 v[130:131], v13 offset0:75 offset1:79
    ds_read2st64_b32 v[132:133], v13 offset0:99 offset1:103
    ds_read2st64_b32 v[134:135], v13 offset0:107 offset1:111
    s_waitcnt lgkmcnt(8)
    v_mfma_f32_32x32x16_bf16 v[168:183], v[112:115], v[152:155], 0
    ds_read_b128 v[160:163], v15 offset:32768
    ds_read_b128 v[164:167], v16 offset:32768
    s_mov_b32 s43, s26
    buffer_load_dwordx4 a[0:3], v10, s[8:11], s43 offen offset:0
    v_mfma_f32_32x32x16_bf16 v[168:183], v[116:119], v[156:159], v[168:183]
    ds_read2st64_b32 v[136:137], v14 offset0:2 offset1:6
    ds_read2st64_b32 v[138:139], v14 offset0:10 offset1:14
    buffer_load_dwordx4 a[4:7], v10, s[8:11], s43 offen offset:1024
    s_waitcnt lgkmcnt(8)
    v_mfma_f32_32x32x16_bf16 v[168:183], v[120:123], v[96:99], v[168:183]
    ds_read2st64_b32 v[140:141], v14 offset0:34 offset1:38
    ds_read2st64_b32 v[142:143], v14 offset0:42 offset1:46
    v_mfma_f32_32x32x16_bf16 v[168:183], v[124:127], v[100:103], v[168:183]
    ds_read2st64_b32 v[144:145], v14 offset0:66 offset1:70
    ds_read2st64_b32 v[146:147], v14 offset0:74 offset1:78
    buffer_load_dwordx4 a[8:11], v10, s[8:11], s43 offen offset:2048
    s_waitcnt lgkmcnt(8)
    v_mfma_f32_32x32x16_bf16 v[168:183], v[128:131], v[104:107], v[168:183]
    ds_read2st64_b32 v[148:149], v14 offset0:98 offset1:102
    v_mfma_f32_32x32x16_bf16 v[168:183], v[132:135], v[108:111], v[168:183]
    ds_read2st64_b32 v[150:151], v14 offset0:106 offset1:110
    buffer_load_dwordx4 a[12:15], v10, s[8:11], s43 offen offset:3072
    s_add_u32 s43, s43, 4096
    s_waitcnt vmcnt(10)
    s_barrier
    s_waitcnt lgkmcnt(8)
    v_mfma_f32_32x32x16_bf16 v[184:199], v[112:115], v[160:163], 0
    ds_read_b128 v[152:155], v17 offset:32768
    ds_read_b128 v[156:159], v18 offset:32768
    buffer_load_dwordx4 a[16:19], v10, s[8:11], s43 offen offset:0
    v_mfma_f32_32x32x16_bf16 v[184:199], v[116:119], v[164:167], v[184:199]
s_nop 0
    v_cvt_pk_bf16_f32 v32, v168, v169
    v_cvt_pk_bf16_f32 v33, v170, v171
    ds_write_b64 v23, v[32:33] offset:24576
    ds_read2st64_b32 v[120:121], v13 offset0:2 offset1:6
    buffer_load_dwordx4 a[20:23], v10, s[8:11], s43 offen offset:1024
    s_waitcnt lgkmcnt(8)
    v_mfma_f32_32x32x16_bf16 v[184:199], v[136:139], v[96:99], v[184:199]
    ds_read2st64_b32 v[122:123], v13 offset0:10 offset1:14
    v_cvt_pk_bf16_f32 v34, v172, v173
    v_cvt_pk_bf16_f32 v35, v174, v175
    ds_write_b64 v24, v[34:35] offset:24576
    v_mfma_f32_32x32x16_bf16 v[184:199], v[140:143], v[100:103], v[184:199]
    ds_read2st64_b32 v[124:125], v13 offset0:34 offset1:38
    buffer_load_dwordx4 a[24:27], v10, s[8:11], s43 offen offset:2048
    s_waitcnt lgkmcnt(7)
    v_mfma_f32_32x32x16_bf16 v[184:199], v[144:147], v[104:107], v[184:199]
    v_cvt_pk_bf16_f32 v36, v176, v177
    v_cvt_pk_bf16_f32 v37, v178, v179
    ds_write_b64 v25, v[36:37] offset:24576
    ds_read2st64_b32 v[126:127], v13 offset0:42 offset1:46
    v_mfma_f32_32x32x16_bf16 v[184:199], v[148:151], v[108:111], v[184:199]
    ds_read2st64_b32 v[128:129], v13 offset0:66 offset1:70
    v_cvt_pk_bf16_f32 v38, v180, v181
    v_cvt_pk_bf16_f32 v39, v182, v183
    ds_write_b64 v26, v[38:39] offset:24576
    buffer_load_dwordx4 a[28:31], v10, s[8:11], s43 offen offset:3072
    s_add_u32 s43, s43, 4096
    v_mfma_f32_32x32x16_bf16 v[224:239], v[220:223], v[32:35], 0
    ds_read2st64_b32 v[130:131], v13 offset0:74 offset1:78
    v_mfma_f32_32x32x16_bf16 v[224:239], v[220:223], v[36:39], v[224:239]
    ds_read2st64_b32 v[132:133], v13 offset0:98 offset1:102
    ds_read2st64_b32 v[134:135], v13 offset0:106 offset1:110
    buffer_load_dwordx4 a[32:35], v10, s[8:11], s43 offen offset:0
    s_waitcnt lgkmcnt(12)
    v_mfma_f32_32x32x16_bf16 v[168:183], v[112:115], v[152:155], 0
    ds_read_b128 v[160:163], v15 offset:40960
    ds_read_b128 v[164:167], v16 offset:40960
    buffer_load_dwordx4 a[36:39], v10, s[8:11], s43 offen offset:1024
    v_mfma_f32_32x32x16_bf16 v[168:183], v[116:119], v[156:159], v[168:183]
    v_cvt_pk_bf16_f32 v40, v184, v185
    v_cvt_pk_bf16_f32 v41, v186, v187
    ds_write_b64 v19, v[40:41] offset:32768
    ds_read2st64_b32 v[136:137], v14 offset0:1 offset1:5
    buffer_load_dwordx4 a[40:43], v10, s[8:11], s43 offen offset:2048
    s_waitcnt lgkmcnt(9)
    v_mfma_f32_32x32x16_bf16 v[168:183], v[120:123], v[96:99], v[168:183]
    ds_read2st64_b32 v[138:139], v14 offset0:9 offset1:13
    v_cvt_pk_bf16_f32 v42, v188, v189
    v_cvt_pk_bf16_f32 v43, v190, v191
    ds_write_b64 v20, v[42:43] offset:32768
    v_mfma_f32_32x32x16_bf16 v[168:183], v[124:127], v[100:103], v[168:183]
    ds_read2st64_b32 v[140:141], v14 offset0:33 offset1:37
    buffer_load_dwordx4 a[44:47], v10, s[8:11], s43 offen offset:3072
    s_add_u32 s43, s43, 4096
    s_waitcnt lgkmcnt(7)
    v_mfma_f32_32x32x16_bf16 v[168:183], v[128:131], v[104:107], v[168:183]
    v_cvt_pk_bf16_f32 v44, v192, v193
    v_cvt_pk_bf16_f32 v45, v194, v195
    ds_write_b64 v21, v[44:45] offset:32768
    ds_read2st64_b32 v[142:143], v14 offset0:41 offset1:45
    v_mfma_f32_32x32x16_bf16 v[168:183], v[132:135], v[108:111], v[168:183]
    ds_read2st64_b32 v[144:145], v14 offset0:65 offset1:69
    v_cvt_pk_bf16_f32 v46, v196, v197
    v_cvt_pk_bf16_f32 v47, v198, v199
    ds_write_b64 v22, v[46:47] offset:32768
    buffer_load_dwordx4 a[48:51], v10, s[8:11], s43 offen offset:0
    v_mfma_f32_32x32x16_bf16 v[224:239], v[220:223], v[40:43], v[224:239]
    ds_read2st64_b32 v[146:147], v14 offset0:73 offset1:77
    v_mfma_f32_32x32x16_bf16 v[224:239], v[220:223], v[44:47], v[224:239]
    ds_read2st64_b32 v[148:149], v14 offset0:97 offset1:101
    ds_read2st64_b32 v[150:151], v14 offset0:105 offset1:109
    buffer_load_dwordx4 a[52:55], v10, s[8:11], s43 offen offset:1024
    s_waitcnt vmcnt(16)
    s_barrier
    s_waitcnt lgkmcnt(12)
    v_mfma_f32_32x32x16_bf16 v[184:199], v[112:115], v[160:163], 0
    ds_read_b128 v[152:155], v17 offset:40960
    ds_read_b128 v[156:159], v18 offset:40960
    buffer_load_dwordx4 a[56:59], v10, s[8:11], s43 offen offset:2048
    v_mfma_f32_32x32x16_bf16 v[184:199], v[116:119], v[164:167], v[184:199]
    v_cvt_pk_bf16_f32 v48, v168, v169
    v_cvt_pk_bf16_f32 v49, v170, v171
    ds_write_b64 v23, v[48:49] offset:32768
    ds_read2st64_b32 v[120:121], v13 offset0:1 offset1:5
    buffer_load_dwordx4 a[60:63], v10, s[8:11], s43 offen offset:3072
    s_add_u32 s43, s43, 4096
    s_waitcnt lgkmcnt(9)
    v_mfma_f32_32x32x16_bf16 v[184:199], v[136:139], v[96:99], v[184:199]
    ds_read2st64_b32 v[122:123], v13 offset0:9 offset1:13
    v_cvt_pk_bf16_f32 v50, v172, v173
    v_cvt_pk_bf16_f32 v51, v174, v175
    ds_write_b64 v24, v[50:51] offset:32768
    v_mfma_f32_32x32x16_bf16 v[184:199], v[140:143], v[100:103], v[184:199]
    ds_read2st64_b32 v[124:125], v13 offset0:33 offset1:37
    buffer_load_dwordx4 a[64:67], v10, s[8:11], s43 offen offset:0
    s_waitcnt lgkmcnt(7)
    v_mfma_f32_32x32x16_bf16 v[184:199], v[144:147], v[104:107], v[184:199]
    v_cvt_pk_bf16_f32 v52, v176, v177
    v_cvt_pk_bf16_f32 v53, v178, v179
    ds_write_b64 v25, v[52:53] offset:32768
    ds_read2st64_b32 v[126:127], v13 offset0:41 offset1:45
    v_mfma_f32_32x32x16_bf16 v[184:199], v[148:151], v[108:111], v[184:199]
    ds_read2st64_b32 v[128:129], v13 offset0:65 offset1:69
    v_cvt_pk_bf16_f32 v54, v180, v181
    v_cvt_pk_bf16_f32 v55, v182, v183
    ds_write_b64 v26, v[54:55] offset:32768
    buffer_load_dwordx4 a[68:71], v10, s[8:11], s43 offen offset:1024
    v_mfma_f32_32x32x16_bf16 v[224:239], v[220:223], v[48:51], v[224:239]
    ds_read2st64_b32 v[130:131], v13 offset0:73 offset1:77
    v_mfma_f32_32x32x16_bf16 v[224:239], v[220:223], v[52:55], v[224:239]
    ds_read2st64_b32 v[132:133], v13 offset0:97 offset1:101
    ds_read2st64_b32 v[134:135], v13 offset0:105 offset1:109
    buffer_load_dwordx4 a[72:75], v10, s[8:11], s43 offen offset:2048
    s_waitcnt lgkmcnt(12)
    v_mfma_f32_32x32x16_bf16 v[168:183], v[112:115], v[152:155], 0
    ds_read_b128 v[160:163], v15 offset:49152
    ds_read_b128 v[164:167], v16 offset:49152
    buffer_load_dwordx4 a[76:79], v10, s[8:11], s43 offen offset:3072
    s_add_u32 s43, s43, 4096
    v_mfma_f32_32x32x16_bf16 v[168:183], v[116:119], v[156:159], v[168:183]
    v_cvt_pk_bf16_f32 v56, v184, v185
    v_cvt_pk_bf16_f32 v57, v186, v187
    ds_write_b64 v19, v[56:57] offset:40960
    ds_read2st64_b32 v[136:137], v14 offset0:0 offset1:4
    buffer_load_dwordx4 a[80:83], v10, s[8:11], s43 offen offset:0
    s_waitcnt lgkmcnt(9)
    v_mfma_f32_32x32x16_bf16 v[168:183], v[120:123], v[96:99], v[168:183]
    ds_read2st64_b32 v[138:139], v14 offset0:8 offset1:12
    v_cvt_pk_bf16_f32 v58, v188, v189
    v_cvt_pk_bf16_f32 v59, v190, v191
    ds_write_b64 v20, v[58:59] offset:40960
    v_mfma_f32_32x32x16_bf16 v[168:183], v[124:127], v[100:103], v[168:183]
    ds_read2st64_b32 v[140:141], v14 offset0:32 offset1:36
    buffer_load_dwordx4 a[84:87], v10, s[8:11], s43 offen offset:1024
    s_waitcnt lgkmcnt(7)
    v_mfma_f32_32x32x16_bf16 v[168:183], v[128:131], v[104:107], v[168:183]
    v_cvt_pk_bf16_f32 v60, v192, v193
    v_cvt_pk_bf16_f32 v61, v194, v195
    ds_write_b64 v21, v[60:61] offset:40960
    ds_read2st64_b32 v[142:143], v14 offset0:40 offset1:44
    v_mfma_f32_32x32x16_bf16 v[168:183], v[132:135], v[108:111], v[168:183]
    ds_read2st64_b32 v[144:145], v14 offset0:64 offset1:68
    v_cvt_pk_bf16_f32 v62, v196, v197
    v_cvt_pk_bf16_f32 v63, v198, v199
    ds_write_b64 v22, v[62:63] offset:40960
    buffer_load_dwordx4 a[88:91], v10, s[8:11], s43 offen offset:2048
    v_mfma_f32_32x32x16_bf16 v[224:239], v[220:223], v[56:59], v[224:239]
    ds_read2st64_b32 v[146:147], v14 offset0:72 offset1:76
    v_mfma_f32_32x32x16_bf16 v[224:239], v[220:223], v[60:63], v[224:239]
    ds_read2st64_b32 v[148:149], v14 offset0:96 offset1:100
    ds_read2st64_b32 v[150:151], v14 offset0:104 offset1:108
    buffer_load_dwordx4 a[92:95], v10, s[8:11], s43 offen offset:3072
    s_add_u32 s43, s43, 4096
    s_waitcnt lgkmcnt(12)
    v_mfma_f32_32x32x16_bf16 v[184:199], v[112:115], v[160:163], 0
    ds_read_b128 v[152:155], v17 offset:49152
    ds_read_b128 v[156:159], v18 offset:49152
    buffer_load_dwordx4 a[96:99], v10, s[8:11], s43 offen offset:0
    v_mfma_f32_32x32x16_bf16 v[184:199], v[116:119], v[164:167], v[184:199]
    v_cvt_pk_bf16_f32 v64, v168, v169
    v_cvt_pk_bf16_f32 v65, v170, v171
    ds_write_b64 v23, v[64:65] offset:40960
    ds_read2st64_b32 v[120:121], v13 offset0:0 offset1:4
    buffer_load_dwordx4 a[100:103], v10, s[8:11], s43 offen offset:1024
    s_waitcnt lgkmcnt(9)
    v_mfma_f32_32x32x16_bf16 v[184:199], v[136:139], v[96:99], v[184:199]
    ds_read2st64_b32 v[122:123], v13 offset0:8 offset1:12
    v_cvt_pk_bf16_f32 v66, v172, v173
    v_cvt_pk_bf16_f32 v67, v174, v175
    ds_write_b64 v24, v[66:67] offset:40960
    v_mfma_f32_32x32x16_bf16 v[184:199], v[140:143], v[100:103], v[184:199]
    ds_read2st64_b32 v[124:125], v13 offset0:32 offset1:36
    buffer_load_dwordx4 a[104:107], v10, s[8:11], s43 offen offset:2048
    s_waitcnt lgkmcnt(7)
    v_mfma_f32_32x32x16_bf16 v[184:199], v[144:147], v[104:107], v[184:199]
    v_cvt_pk_bf16_f32 v68, v176, v177
    v_cvt_pk_bf16_f32 v69, v178, v179
    ds_write_b64 v25, v[68:69] offset:40960
    ds_read2st64_b32 v[126:127], v13 offset0:40 offset1:44
    v_mfma_f32_32x32x16_bf16 v[184:199], v[148:151], v[108:111], v[184:199]
    ds_read2st64_b32 v[128:129], v13 offset0:64 offset1:68
    v_cvt_pk_bf16_f32 v70, v180, v181
    v_cvt_pk_bf16_f32 v71, v182, v183
    ds_write_b64 v26, v[70:71] offset:40960
    buffer_load_dwordx4 a[108:111], v10, s[8:11], s43 offen offset:3072
    s_add_u32 s43, s43, 4096
    v_mfma_f32_32x32x16_bf16 v[224:239], v[220:223], v[64:67], v[224:239]
    ds_read2st64_b32 v[130:131], v13 offset0:72 offset1:76
    v_mfma_f32_32x32x16_bf16 v[224:239], v[220:223], v[68:71], v[224:239]
    ds_read2st64_b32 v[132:133], v13 offset0:96 offset1:100
    ds_read2st64_b32 v[134:135], v13 offset0:104 offset1:108
    buffer_load_dwordx4 a[112:115], v10, s[8:11], s43 offen offset:0
    s_waitcnt lgkmcnt(12)
    v_mfma_f32_32x32x16_bf16 v[168:183], v[112:115], v[152:155], 0
    buffer_load_dwordx4 a[116:119], v10, s[8:11], s43 offen offset:1024
    v_mfma_f32_32x32x16_bf16 v[168:183], v[116:119], v[156:159], v[168:183]
    v_cvt_pk_bf16_f32 v72, v184, v185
    v_cvt_pk_bf16_f32 v73, v186, v187
    ds_write_b64 v19, v[72:73] offset:49152
    buffer_load_dwordx4 a[120:123], v10, s[8:11], s43 offen offset:2048
    s_waitcnt lgkmcnt(6)
    v_mfma_f32_32x32x16_bf16 v[168:183], v[120:123], v[96:99], v[168:183]
    v_cvt_pk_bf16_f32 v74, v188, v189
    v_cvt_pk_bf16_f32 v75, v190, v191
    ds_write_b64 v20, v[74:75] offset:49152
    v_mfma_f32_32x32x16_bf16 v[168:183], v[124:127], v[100:103], v[168:183]
    buffer_load_dwordx4 a[124:127], v10, s[8:11], s43 offen offset:3072
    s_add_u32 s43, s43, 4096
    s_waitcnt lgkmcnt(2)
    v_mfma_f32_32x32x16_bf16 v[168:183], v[128:131], v[104:107], v[168:183]
    v_cvt_pk_bf16_f32 v76, v192, v193
    v_cvt_pk_bf16_f32 v77, v194, v195
    ds_write_b64 v21, v[76:77] offset:49152
    v_mfma_f32_32x32x16_bf16 v[168:183], v[132:135], v[108:111], v[168:183]
    v_cvt_pk_bf16_f32 v78, v196, v197
    v_cvt_pk_bf16_f32 v79, v198, v199
    ds_write_b64 v22, v[78:79] offset:49152
    buffer_load_dwordx4 a[128:131], v10, s[8:11], s43 offen offset:0
    v_mfma_f32_32x32x16_bf16 v[224:239], v[220:223], v[72:75], v[224:239]
    v_mfma_f32_32x32x16_bf16 v[224:239], v[220:223], v[76:79], v[224:239]
    buffer_load_dwordx4 a[132:135], v10, s[8:11], s43 offen offset:1024
s_nop 4
    v_cvt_pk_bf16_f32 v80, v168, v169
    v_cvt_pk_bf16_f32 v81, v170, v171
    ds_write_b64 v23, v[80:81] offset:49152
    v_cvt_pk_bf16_f32 v82, v172, v173
    v_cvt_pk_bf16_f32 v83, v174, v175
    ds_write_b64 v24, v[82:83] offset:49152
    v_cvt_pk_bf16_f32 v84, v176, v177
    v_cvt_pk_bf16_f32 v85, v178, v179
    ds_write_b64 v25, v[84:85] offset:49152
    v_cvt_pk_bf16_f32 v86, v180, v181
    v_cvt_pk_bf16_f32 v87, v182, v183
    ds_write_b64 v26, v[86:87] offset:49152
    v_mfma_f32_32x32x16_bf16 v[224:239], v[220:223], v[80:83], v[224:239]
    v_mfma_f32_32x32x16_bf16 v[224:239], v[220:223], v[84:87], v[224:239]
L_k2_p2done:
    v_and_b32 v2, 31, v1
    s_lshl_b32 s45, s37, 5
    s_lshl_b32 s46, s38, 6
    s_add_u32 s45, s45, s46
    v_add_u32 v2, s45, v2
    v_lshlrev_b32 v2, 2, v2
    v_add_u32 v2, 123136, v2
s_nop 4
    ds_write_b32 v2, v224
    s_lshl_b32 s45, s37, 12
    v_subrev_u32 v208, s45, v15
    v_subrev_u32 v209, s45, v16
    v_subrev_u32 v210, s45, v17
    v_subrev_u32 v211, s45, v18
    s_waitcnt lgkmcnt(0)
    s_barrier
    ds_read_b128 v[160:163], v208 offset:0
    ds_read_b128 v[164:167], v208 offset:4096
    ds_read_b128 v[168:171], v209 offset:0
    ds_read_b128 v[172:175], v209 offset:4096
    v_and_b32 v2, 31, v1
    v_lshlrev_b32 v2, 2, v2
    v_add_u32 v2, 123136, v2
    ds_read_b32 v4, v2
    ds_read_b32 v5, v2 offset:128
    ds_read_b32 v6, v2 offset:256
    ds_read_b32 v7, v2 offset:384
    s_waitcnt vmcnt(30) lgkmcnt(6)
    v_mfma_f32_32x32x16_bf16 v[96:111], a[0:3], v[160:163], 0
    ds_read_b128 v[224:227], v210 offset:0
    ds_read_b128 v[228:231], v210 offset:4096
    s_waitcnt lgkmcnt(2)
    v_mfma_f32_32x32x16_bf16 v[112:127], a[0:3], v[164:167], 0
    buffer_load_dwordx4 a[136:139], v10, s[8:11], s43 offen offset:2048
    v_add_f32 v6, v4, v6
    v_add_f32 v7, v5, v7
    v_mul_f32 v6, 0xbb124925, v6
    v_mfma_f32_32x32x16_bf16 v[96:111], a[4:7], v[168:171], v[96:111]
    ds_read_b128 v[160:163], v211 offset:0
    ds_read_b128 v[164:167], v211 offset:4096
    v_mul_f32 v7, 0xbb124925, v7
    v_mfma_f32_32x32x16_bf16 v[112:127], a[4:7], v[172:175], v[112:127]
    buffer_load_dwordx4 a[140:143], v10, s[8:11], s43 offen offset:3072
    s_add_u32 s43, s43, 4096
    v_cvt_pk_bf16_f32 v2, v6, v6
    v_and_b32 v2, 0xffff0000, v2
    v_sub_f32 v3, v6, v2
    s_waitcnt lgkmcnt(2)
    v_mfma_f32_32x32x16_bf16 v[96:111], a[8:11], v[224:227], v[96:111]
    ds_read_b128 v[168:171], v208 offset:8192
    ds_read_b128 v[172:175], v208 offset:12288
    v_cvt_pk_bf16_f32 v188, v2, v3
    v_mfma_f32_32x32x16_bf16 v[112:127], a[8:11], v[228:231], v[112:127]
    buffer_load_dwordx4 a[144:147], v10, s[8:11], s43 offen offset:0
    v_lshrrev_b32 v189, 16, v2
    v_mov_b32 v190, 0
    v_mov_b32 v191, 0
    s_waitcnt lgkmcnt(2)
    v_mfma_f32_32x32x16_bf16 v[96:111], a[12:15], v[160:163], v[96:111]
    ds_read_b128 v[224:227], v209 offset:8192
    ds_read_b128 v[228:231], v209 offset:12288
    v_cvt_pk_bf16_f32 v2, v7, v7
    v_mfma_f32_32x32x16_bf16 v[112:127], a[12:15], v[164:167], v[112:127]
    buffer_load_dwordx4 a[148:151], v10, s[8:11], s43 offen offset:1024
    v_and_b32 v2, 0xffff0000, v2
    v_sub_f32 v3, v7, v2
    v_cvt_pk_bf16_f32 v192, v2, v3
    s_waitcnt vmcnt(30) lgkmcnt(2)
    v_mfma_f32_32x32x16_bf16 v[96:111], a[16:19], v[168:171], v[96:111]
    ds_read_b128 v[160:163], v210 offset:8192
    ds_read_b128 v[164:167], v210 offset:12288
    v_lshrrev_b32 v193, 16, v2
    v_mfma_f32_32x32x16_bf16 v[112:127], a[16:19], v[172:175], v[112:127]
    buffer_load_dwordx4 a[152:155], v10, s[8:11], s43 offen offset:2048
    v_mov_b32 v194, 0
    v_mov_b32 v195, 0
    s_waitcnt lgkmcnt(2)
    v_mfma_f32_32x32x16_bf16 v[96:111], a[20:23], v[224:227], v[96:111]
    ds_read_b128 v[168:171], v211 offset:8192
    ds_read_b128 v[172:175], v211 offset:12288
    v_cmp_eq_u32 vcc, 0, v30
    v_mfma_f32_32x32x16_bf16 v[112:127], a[20:23], v[228:231], v[112:127]
    buffer_load_dwordx4 a[156:159], v10, s[8:11], s43 offen offset:3072
    s_add_u32 s43, s43, 4096
    s_nop 1
    v_cndmask_b32 v2, 0, v216, vcc
    v_cvt_pk_bf16_f32 v180, v2, v2
    s_waitcnt lgkmcnt(2)
    v_mfma_f32_32x32x16_bf16 v[96:111], a[24:27], v[160:163], v[96:111]
    ds_read_b128 v[224:227], v208 offset:16384
    ds_read_b128 v[228:231], v208 offset:20480
    v_and_b32 v4, 0xffff0000, v180
    v_mfma_f32_32x32x16_bf16 v[112:127], a[24:27], v[164:167], v[112:127]
    buffer_load_dwordx4 a[160:163], v10, s[8:11], s43 offen offset:0
    v_sub_f32 v4, v2, v4
    v_mov_b32 v5, 0
    v_cvt_pk_bf16_f32 v181, v4, v5
    s_waitcnt lgkmcnt(2)
    v_mfma_f32_32x32x16_bf16 v[96:111], a[28:31], v[168:171], v[96:111]
    ds_read_b128 v[160:163], v209 offset:16384
    ds_read_b128 v[164:167], v209 offset:20480
    v_mov_b32 v182, 0
    v_mfma_f32_32x32x16_bf16 v[112:127], a[28:31], v[172:175], v[112:127]
    buffer_load_dwordx4 a[164:167], v10, s[8:11], s43 offen offset:1024
    v_mov_b32 v183, 0
    v_cndmask_b32 v2, 0, v217, vcc
    v_cvt_pk_bf16_f32 v184, v2, v2
    s_waitcnt vmcnt(30) lgkmcnt(2)
    v_mfma_f32_32x32x16_bf16 v[96:111], a[32:35], v[224:227], v[96:111]
    ds_read_b128 v[168:171], v210 offset:16384
    ds_read_b128 v[172:175], v210 offset:20480
    v_and_b32 v4, 0xffff0000, v184
    v_mfma_f32_32x32x16_bf16 v[112:127], a[32:35], v[228:231], v[112:127]
    buffer_load_dwordx4 a[168:171], v10, s[8:11], s43 offen offset:2048
    v_sub_f32 v4, v2, v4
    v_mov_b32 v5, 0
    v_cvt_pk_bf16_f32 v185, v4, v5
    s_waitcnt lgkmcnt(2)
    v_mfma_f32_32x32x16_bf16 v[96:111], a[36:39], v[160:163], v[96:111]
    ds_read_b128 v[224:227], v211 offset:16384
    ds_read_b128 v[228:231], v211 offset:20480
    v_mov_b32 v186, 0
    v_mfma_f32_32x32x16_bf16 v[112:127], a[36:39], v[164:167], v[112:127]
    buffer_load_dwordx4 a[172:175], v10, s[8:11], s43 offen offset:3072
    s_add_u32 s43, s43, 4096
    v_mov_b32 v187, 0
    v_and_b32 v2, 15, v1
    v_lshlrev_b32 v2, 4, v2
    s_waitcnt lgkmcnt(2)
    v_mfma_f32_32x32x16_bf16 v[96:111], a[40:43], v[168:171], v[96:111]
    ds_read_b128 v[160:163], v208 offset:24576
    ds_read_b128 v[164:167], v208 offset:28672
    v_bfe_u32 v3, v1, 4, 1
    v_mfma_f32_32x32x16_bf16 v[112:127], a[40:43], v[172:175], v[112:127]
    buffer_load_dwordx4 a[176:179], v10, s[8:11], s43 offen offset:0
    v_lshl_add_u32 v2, v3, 10, v2
    v_lshl_add_u32 v2, v30, 8, v2
    s_lshl_b32 s45, s36, 13
    s_waitcnt lgkmcnt(2)
    v_mfma_f32_32x32x16_bf16 v[96:111], a[44:47], v[224:227], v[96:111]
    ds_read_b128 v[168:171], v209 offset:24576
    ds_read_b128 v[172:175], v209 offset:28672
    s_add_u32 s45, s45, 57600
    v_mfma_f32_32x32x16_bf16 v[112:127], a[44:47], v[228:231], v[112:127]
    buffer_load_dwordx4 a[180:183], v10, s[8:11], s43 offen offset:1024
    v_add_u32 v212, s45, v2
    s_waitcnt vmcnt(30) lgkmcnt(2)
    v_mfma_f32_32x32x16_bf16 v[96:111], a[48:51], v[160:163], v[96:111]
    ds_read_b128 v[224:227], v210 offset:24576
    ds_read_b128 v[228:231], v210 offset:28672
    v_mfma_f32_32x32x16_bf16 v[112:127], a[48:51], v[164:167], v[112:127]
    buffer_load_dwordx4 a[184:187], v10, s[8:11], s43 offen offset:2048
    s_waitcnt lgkmcnt(2)
    v_mfma_f32_32x32x16_bf16 v[96:111], a[52:55], v[168:171], v[96:111]
    ds_read_b128 v[160:163], v211 offset:24576
    ds_read_b128 v[164:167], v211 offset:28672
    v_mfma_f32_32x32x16_bf16 v[112:127], a[52:55], v[172:175], v[112:127]
    buffer_load_dwordx4 a[188:191], v10, s[8:11], s43 offen offset:3072
    s_add_u32 s43, s43, 4096
    s_waitcnt lgkmcnt(2)
    v_mfma_f32_32x32x16_bf16 v[96:111], a[56:59], v[224:227], v[96:111]
    ds_read_b128 v[168:171], v208 offset:32768
    ds_read_b128 v[172:175], v208 offset:36864
    v_mfma_f32_32x32x16_bf16 v[112:127], a[56:59], v[228:231], v[112:127]
    buffer_load_dwordx4 a[192:195], v10, s[8:11], s43 offen offset:0
    s_waitcnt lgkmcnt(2)
    v_mfma_f32_32x32x16_bf16 v[96:111], a[60:63], v[160:163], v[96:111]
    ds_read_b128 v[224:227], v209 offset:32768
    ds_read_b128 v[228:231], v209 offset:36864
    v_mfma_f32_32x32x16_bf16 v[112:127], a[60:63], v[164:167], v[112:127]
    buffer_load_dwordx4 a[196:199], v10, s[8:11], s43 offen offset:1024
    s_waitcnt vmcnt(30) lgkmcnt(2)
    v_mfma_f32_32x32x16_bf16 v[96:111], a[64:67], v[168:171], v[96:111]
    ds_read_b128 v[160:163], v210 offset:32768
    ds_read_b128 v[164:167], v210 offset:36864
    v_mfma_f32_32x32x16_bf16 v[112:127], a[64:67], v[172:175], v[112:127]
    buffer_load_dwordx4 a[200:203], v10, s[8:11], s43 offen offset:2048
    s_waitcnt lgkmcnt(2)
    v_mfma_f32_32x32x16_bf16 v[96:111], a[68:71], v[224:227], v[96:111]
    ds_read_b128 v[168:171], v211 offset:32768
    ds_read_b128 v[172:175], v211 offset:36864
    v_mfma_f32_32x32x16_bf16 v[112:127], a[68:71], v[228:231], v[112:127]
    buffer_load_dwordx4 a[204:207], v10, s[8:11], s43 offen offset:3072
    s_add_u32 s43, s43, 4096
    s_waitcnt lgkmcnt(2)
    v_mfma_f32_32x32x16_bf16 v[96:111], a[72:75], v[160:163], v[96:111]
    ds_read_b128 v[224:227], v208 offset:40960
    ds_read_b128 v[228:231], v208 offset:45056
    v_mfma_f32_32x32x16_bf16 v[112:127], a[72:75], v[164:167], v[112:127]
    buffer_load_dwordx4 a[208:211], v10, s[8:11], s43 offen offset:0
    s_waitcnt lgkmcnt(2)
    v_mfma_f32_32x32x16_bf16 v[96:111], a[76:79], v[168:171], v[96:111]
    ds_read_b128 v[160:163], v209 offset:40960
    ds_read_b128 v[164:167], v209 offset:45056
    v_mfma_f32_32x32x16_bf16 v[112:127], a[76:79], v[172:175], v[112:127]
    buffer_load_dwordx4 a[212:215], v10, s[8:11], s43 offen offset:1024
    s_waitcnt vmcnt(30) lgkmcnt(2)
    v_mfma_f32_32x32x16_bf16 v[96:111], a[80:83], v[224:227], v[96:111]
    ds_read_b128 v[168:171], v210 offset:40960
    ds_read_b128 v[172:175], v210 offset:45056
    v_mfma_f32_32x32x16_bf16 v[112:127], a[80:83], v[228:231], v[112:127]
    buffer_load_dwordx4 a[216:219], v10, s[8:11], s43 offen offset:2048
    s_waitcnt lgkmcnt(2)
    v_mfma_f32_32x32x16_bf16 v[96:111], a[84:87], v[160:163], v[96:111]
    ds_read_b128 v[224:227], v211 offset:40960
    ds_read_b128 v[228:231], v211 offset:45056
    v_mfma_f32_32x32x16_bf16 v[112:127], a[84:87], v[164:167], v[112:127]
    buffer_load_dwordx4 a[220:223], v10, s[8:11], s43 offen offset:3072
    s_add_u32 s43, s43, 4096
    s_waitcnt lgkmcnt(2)
    v_mfma_f32_32x32x16_bf16 v[96:111], a[88:91], v[168:171], v[96:111]
    ds_read_b128 v[160:163], v208 offset:49152
    ds_read_b128 v[164:167], v208 offset:53248
    v_mfma_f32_32x32x16_bf16 v[112:127], a[88:91], v[172:175], v[112:127]
    s_add_u32 s25, s40, 1
    s_cmp_eq_u32 s25, 7
    s_cselect_b32 s25, 0, s25
    s_lshl_b32 s25, s25, 13
    s_add_u32 s43, s52, s25
    buffer_load_dwordx4 a[0:3], v10, s[8:11], s43 offen offset:0
    s_waitcnt lgkmcnt(2)
    v_mfma_f32_32x32x16_bf16 v[96:111], a[92:95], v[224:227], v[96:111]
    ds_read_b128 v[168:171], v209 offset:49152
    ds_read_b128 v[172:175], v209 offset:53248
    v_mfma_f32_32x32x16_bf16 v[112:127], a[92:95], v[228:231], v[112:127]
    buffer_load_dwordx4 a[4:7], v10, s[8:11], s43 offen offset:1024
    s_waitcnt vmcnt(30) lgkmcnt(2)
    v_mfma_f32_32x32x16_bf16 v[96:111], a[96:99], v[160:163], v[96:111]
    ds_read_b128 v[224:227], v210 offset:49152
    ds_read_b128 v[228:231], v210 offset:53248
    v_mfma_f32_32x32x16_bf16 v[112:127], a[96:99], v[164:167], v[112:127]
    buffer_load_dwordx4 a[8:11], v10, s[8:11], s43 offen offset:2048
    s_waitcnt lgkmcnt(2)
    v_mfma_f32_32x32x16_bf16 v[96:111], a[100:103], v[168:171], v[96:111]
    ds_read_b128 v[160:163], v211 offset:49152
    ds_read_b128 v[164:167], v211 offset:53248
    v_mfma_f32_32x32x16_bf16 v[112:127], a[100:103], v[172:175], v[112:127]
    buffer_load_dwordx4 a[12:15], v10, s[8:11], s43 offen offset:3072
    s_waitcnt lgkmcnt(2)
    v_mfma_f32_32x32x16_bf16 v[96:111], a[104:107], v[224:227], v[96:111]
    ds_read_b128 v[168:171], v208 offset:0
    ds_read_b128 v[172:175], v208 offset:4096
    v_mfma_f32_32x32x16_bf16 v[112:127], a[104:107], v[228:231], v[112:127]
    s_add_u32 s43, s43, 4096
    buffer_load_dwordx4 a[16:19], v10, s[8:11], s43 offen offset:0
    s_waitcnt lgkmcnt(2)
    v_mfma_f32_32x32x16_bf16 v[96:111], a[108:111], v[160:163], v[96:111]
    ds_read_b128 v[224:227], v209 offset:0
    ds_read_b128 v[228:231], v209 offset:4096
    v_mfma_f32_32x32x16_bf16 v[112:127], a[108:111], v[164:167], v[112:127]
    buffer_load_dwordx4 a[20:23], v10, s[8:11], s43 offen offset:1024
    v_mfma_f32_32x32x16_bf16 v[96:111], v[180:183], v[188:191], v[96:111]
    v_mfma_f32_32x32x16_bf16 v[112:127], v[180:183], v[192:195], v[112:127]
    s_waitcnt vmcnt(30) lgkmcnt(2)
    v_mfma_f32_32x32x16_bf16 v[128:143], a[112:115], v[168:171], 0
    ds_read_b128 v[160:163], v210 offset:0
    ds_read_b128 v[164:167], v210 offset:4096
    v_mfma_f32_32x32x16_bf16 v[144:159], a[112:115], v[172:175], 0
    buffer_load_dwordx4 a[24:27], v10, s[8:11], s43 offen offset:2048
s_nop 4
    v_cvt_pk_bf16_f32 v200, v96, v97
    v_cvt_pk_bf16_f32 v201, v98, v99
    v_cvt_pk_bf16_f32 v202, v100, v101
    s_waitcnt lgkmcnt(2)
    v_mfma_f32_32x32x16_bf16 v[128:143], a[116:119], v[224:227], v[128:143]
    ds_read_b128 v[168:171], v211 offset:0
    ds_read_b128 v[172:175], v211 offset:4096
    v_cvt_pk_bf16_f32 v203, v102, v103
    v_mfma_f32_32x32x16_bf16 v[144:159], a[116:119], v[228:231], v[144:159]
    buffer_load_dwordx4 a[28:31], v10, s[8:11], s43 offen offset:3072
    s_add_u32 s25, s25, 8192
    s_cmp_eq_u32 s25, 57344
    s_cselect_b32 s25, 0, s25
    v_pk_max_i16 v200, v200, 0
    v_pk_max_i16 v201, v201, 0
    v_pk_max_i16 v202, v202, 0
    s_waitcnt lgkmcnt(2)
    v_mfma_f32_32x32x16_bf16 v[128:143], a[120:123], v[160:163], v[128:143]
    ds_read_b128 v[224:227], v208 offset:8192
    ds_read_b128 v[228:231], v208 offset:12288
    v_pk_max_i16 v203, v203, 0
    v_mfma_f32_32x32x16_bf16 v[144:159], a[120:123], v[164:167], v[144:159]
    s_add_u32 s43, s52, s25
    buffer_load_dwordx4 a[32:35], v10, s[8:11], s43 offen offset:0
    ds_write_b128 v212, v[200:203] offset:0
    v_cvt_pk_bf16_f32 v204, v104, v105
    v_cvt_pk_bf16_f32 v205, v106, v107
    s_waitcnt lgkmcnt(3)
    v_mfma_f32_32x32x16_bf16 v[128:143], a[124:127], v[168:171], v[128:143]
    ds_read_b128 v[160:163], v209 offset:8192
    ds_read_b128 v[164:167], v209 offset:12288
    v_cvt_pk_bf16_f32 v206, v108, v109
    v_mfma_f32_32x32x16_bf16 v[144:159], a[124:127], v[172:175], v[144:159]
    buffer_load_dwordx4 a[36:39], v10, s[8:11], s43 offen offset:1024
    v_cvt_pk_bf16_f32 v207, v110, v111
    v_pk_max_i16 v204, v204, 0
    v_pk_max_i16 v205, v205, 0
    s_waitcnt vmcnt(30) lgkmcnt(3)
    v_mfma_f32_32x32x16_bf16 v[128:143], a[128:131], v[224:227], v[128:143]
    ds_read_b128 v[168:171], v210 offset:8192
    ds_read_b128 v[172:175], v210 offset:12288
    v_pk_max_i16 v206, v206, 0
    v_mfma_f32_32x32x16_bf16 v[144:159], a[128:131], v[228:231], v[144:159]
    buffer_load_dwordx4 a[40:43], v10, s[8:11], s43 offen offset:2048
    v_pk_max_i16 v207, v207, 0
    ds_write_b128 v212, v[204:207] offset:512
    v_cvt_pk_bf16_f32 v200, v112, v113
    s_waitcnt lgkmcnt(3)
    v_mfma_f32_32x32x16_bf16 v[128:143], a[132:135], v[160:163], v[128:143]
    ds_read_b128 v[224:227], v211 offset:8192
    ds_read_b128 v[228:231], v211 offset:12288
    v_cvt_pk_bf16_f32 v201, v114, v115
    v_mfma_f32_32x32x16_bf16 v[144:159], a[132:135], v[164:167], v[144:159]
    buffer_load_dwordx4 a[44:47], v10, s[8:11], s43 offen offset:3072
    v_cvt_pk_bf16_f32 v202, v116, v117
    v_cvt_pk_bf16_f32 v203, v118, v119
    v_pk_max_i16 v200, v200, 0
    s_waitcnt lgkmcnt(3)
    v_mfma_f32_32x32x16_bf16 v[128:143], a[136:139], v[168:171], v[128:143]
    ds_read_b128 v[160:163], v208 offset:16384
    ds_read_b128 v[164:167], v208 offset:20480
    v_pk_max_i16 v201, v201, 0
    v_mfma_f32_32x32x16_bf16 v[144:159], a[136:139], v[172:175], v[144:159]
    s_add_u32 s43, s43, 4096
    buffer_load_dwordx4 a[48:51], v10, s[8:11], s43 offen offset:0
    v_pk_max_i16 v202, v202, 0
    v_pk_max_i16 v203, v203, 0
    ds_write_b128 v212, v[200:203] offset:2048
    s_waitcnt lgkmcnt(3)
    v_mfma_f32_32x32x16_bf16 v[128:143], a[140:143], v[224:227], v[128:143]
    ds_read_b128 v[168:171], v209 offset:16384
    ds_read_b128 v[172:175], v209 offset:20480
    v_cvt_pk_bf16_f32 v204, v120, v121
    v_mfma_f32_32x32x16_bf16 v[144:159], a[140:143], v[228:231], v[144:159]
    buffer_load_dwordx4 a[52:55], v10, s[8:11], s43 offen offset:1024
    v_cvt_pk_bf16_f32 v205, v122, v123
    v_cvt_pk_bf16_f32 v206, v124, v125
    v_cvt_pk_bf16_f32 v207, v126, v127
    s_waitcnt vmcnt(30) lgkmcnt(3)
    v_mfma_f32_32x32x16_bf16 v[128:143], a[144:147], v[160:163], v[128:143]
    ds_read_b128 v[224:227], v210 offset:16384
    ds_read_b128 v[228:231], v210 offset:20480
    v_pk_max_i16 v204, v204, 0
    v_mfma_f32_32x32x16_bf16 v[144:159], a[144:147], v[164:167], v[144:159]
    buffer_load_dwordx4 a[56:59], v10, s[8:11], s43 offen offset:2048
    v_pk_max_i16 v205, v205, 0
    v_pk_max_i16 v206, v206, 0
    v_pk_max_i16 v207, v207, 0
    s_waitcnt lgkmcnt(2)
    v_mfma_f32_32x32x16_bf16 v[128:143], a[148:151], v[168:171], v[128:143]
    ds_read_b128 v[160:163], v211 offset:16384
    ds_read_b128 v[164:167], v211 offset:20480
    ds_write_b128 v212, v[204:207] offset:2560
    v_mfma_f32_32x32x16_bf16 v[144:159], a[148:151], v[172:175], v[144:159]
    buffer_load_dwordx4 a[60:63], v10, s[8:11], s43 offen offset:3072
    s_add_u32 s25, s25, 8192
    s_cmp_eq_u32 s25, 57344
    s_cselect_b32 s25, 0, s25
    s_waitcnt lgkmcnt(3)
    v_mfma_f32_32x32x16_bf16 v[128:143], a[152:155], v[224:227], v[128:143]
    ds_read_b128 v[168:171], v208 offset:24576
    ds_read_b128 v[172:175], v208 offset:28672
    v_mfma_f32_32x32x16_bf16 v[144:159], a[152:155], v[228:231], v[144:159]
    s_add_u32 s43, s52, s25
    buffer_load_dwordx4 a[64:67], v10, s[8:11], s43 offen offset:0
    s_waitcnt lgkmcnt(3)
    v_mfma_f32_32x32x16_bf16 v[128:143], a[156:159], v[160:163], v[128:143]
    ds_read_b128 v[224:227], v209 offset:24576
    ds_read_b128 v[228:231], v209 offset:28672
    v_mfma_f32_32x32x16_bf16 v[144:159], a[156:159], v[164:167], v[144:159]
    buffer_load_dwordx4 a[68:71], v10, s[8:11], s43 offen offset:1024
    s_waitcnt vmcnt(30) lgkmcnt(2)
    v_mfma_f32_32x32x16_bf16 v[128:143], a[160:163], v[168:171], v[128:143]
    ds_read_b128 v[160:163], v210 offset:24576
    ds_read_b128 v[164:167], v210 offset:28672
    v_mfma_f32_32x32x16_bf16 v[144:159], a[160:163], v[172:175], v[144:159]
    buffer_load_dwordx4 a[72:75], v10, s[8:11], s43 offen offset:2048
    s_waitcnt lgkmcnt(2)
    v_mfma_f32_32x32x16_bf16 v[128:143], a[164:167], v[224:227], v[128:143]
    ds_read_b128 v[168:171], v211 offset:24576
    ds_read_b128 v[172:175], v211 offset:28672
    v_mfma_f32_32x32x16_bf16 v[144:159], a[164:167], v[228:231], v[144:159]
    buffer_load_dwordx4 a[76:79], v10, s[8:11], s43 offen offset:3072
    s_waitcnt lgkmcnt(2)
    v_mfma_f32_32x32x16_bf16 v[128:143], a[168:171], v[160:163], v[128:143]
    ds_read_b128 v[224:227], v208 offset:32768
    ds_read_b128 v[228:231], v208 offset:36864
    v_mfma_f32_32x32x16_bf16 v[144:159], a[168:171], v[164:167], v[144:159]
    s_add_u32 s43, s43, 4096
    buffer_load_dwordx4 a[80:83], v10, s[8:11], s43 offen offset:0
    s_waitcnt lgkmcnt(2)
    v_mfma_f32_32x32x16_bf16 v[128:143], a[172:175], v[168:171], v[128:143]
    ds_read_b128 v[160:163], v209 offset:32768
    ds_read_b128 v[164:167], v209 offset:36864
    v_mfma_f32_32x32x16_bf16 v[144:159], a[172:175], v[172:175], v[144:159]
    buffer_load_dwordx4 a[84:87], v10, s[8:11], s43 offen offset:1024
    s_waitcnt vmcnt(30) lgkmcnt(2)
    v_mfma_f32_32x32x16_bf16 v[128:143], a[176:179], v[224:227], v[128:143]
    ds_read_b128 v[168:171], v210 offset:32768
    ds_read_b128 v[172:175], v210 offset:36864
    v_mfma_f32_32x32x16_bf16 v[144:159], a[176:179], v[228:231], v[144:159]
    buffer_load_dwordx4 a[88:91], v10, s[8:11], s43 offen offset:2048
    s_waitcnt lgkmcnt(2)
    v_mfma_f32_32x32x16_bf16 v[128:143], a[180:183], v[160:163], v[128:143]
    ds_read_b128 v[224:227], v211 offset:32768
    ds_read_b128 v[228:231], v211 offset:36864
    v_mfma_f32_32x32x16_bf16 v[144:159], a[180:183], v[164:167], v[144:159]
    buffer_load_dwordx4 a[92:95], v10, s[8:11], s43 offen offset:3072
    s_add_u32 s25, s25, 8192
    s_cmp_eq_u32 s25, 57344
    s_cselect_b32 s25, 0, s25
    s_waitcnt lgkmcnt(2)
    v_mfma_f32_32x32x16_bf16 v[128:143], a[184:187], v[168:171], v[128:143]
    ds_read_b128 v[160:163], v208 offset:40960
    ds_read_b128 v[164:167], v208 offset:45056
    v_mfma_f32_32x32x16_bf16 v[144:159], a[184:187], v[172:175], v[144:159]
    s_add_u32 s43, s52, s25
    buffer_load_dwordx4 a[96:99], v10, s[8:11], s43 offen offset:0
    s_waitcnt lgkmcnt(2)
    v_mfma_f32_32x32x16_bf16 v[128:143], a[188:191], v[224:227], v[128:143]
    ds_read_b128 v[168:171], v209 offset:40960
    ds_read_b128 v[172:175], v209 offset:45056
    v_mfma_f32_32x32x16_bf16 v[144:159], a[188:191], v[228:231], v[144:159]
    buffer_load_dwordx4 a[100:103], v10, s[8:11], s43 offen offset:1024
    s_waitcnt vmcnt(30) lgkmcnt(2)
    v_mfma_f32_32x32x16_bf16 v[128:143], a[192:195], v[160:163], v[128:143]
    ds_read_b128 v[224:227], v210 offset:40960
    ds_read_b128 v[228:231], v210 offset:45056
    v_mfma_f32_32x32x16_bf16 v[144:159], a[192:195], v[164:167], v[144:159]
    buffer_load_dwordx4 a[104:107], v10, s[8:11], s43 offen offset:2048
    s_waitcnt lgkmcnt(2)
    v_mfma_f32_32x32x16_bf16 v[128:143], a[196:199], v[168:171], v[128:143]
    ds_read_b128 v[160:163], v211 offset:40960
    ds_read_b128 v[164:167], v211 offset:45056
    v_mfma_f32_32x32x16_bf16 v[144:159], a[196:199], v[172:175], v[144:159]
    buffer_load_dwordx4 a[108:111], v10, s[8:11], s43 offen offset:3072
    s_waitcnt lgkmcnt(2)
    v_mfma_f32_32x32x16_bf16 v[128:143], a[200:203], v[224:227], v[128:143]
    ds_read_b128 v[168:171], v208 offset:49152
    ds_read_b128 v[172:175], v208 offset:53248
    v_mfma_f32_32x32x16_bf16 v[144:159], a[200:203], v[228:231], v[144:159]
    s_add_u32 s43, s43, 4096
    buffer_load_dwordx4 v[32:35], v10, s[8:11], s43 offen offset:0
    s_waitcnt lgkmcnt(2)
    v_mfma_f32_32x32x16_bf16 v[128:143], a[204:207], v[160:163], v[128:143]
    ds_read_b128 v[224:227], v209 offset:49152
    ds_read_b128 v[228:231], v209 offset:53248
    v_mfma_f32_32x32x16_bf16 v[144:159], a[204:207], v[164:167], v[144:159]
    buffer_load_dwordx4 v[36:39], v10, s[8:11], s43 offen offset:1024
    s_waitcnt vmcnt(30) lgkmcnt(2)
    v_mfma_f32_32x32x16_bf16 v[128:143], a[208:211], v[168:171], v[128:143]
    ds_read_b128 v[160:163], v210 offset:49152
    ds_read_b128 v[164:167], v210 offset:53248
    v_mfma_f32_32x32x16_bf16 v[144:159], a[208:211], v[172:175], v[144:159]
    buffer_load_dwordx4 v[40:43], v10, s[8:11], s43 offen offset:2048
    s_waitcnt lgkmcnt(2)
    v_mfma_f32_32x32x16_bf16 v[128:143], a[212:215], v[224:227], v[128:143]
    ds_read_b128 v[168:171], v211 offset:49152
    ds_read_b128 v[172:175], v211 offset:53248
    v_mfma_f32_32x32x16_bf16 v[144:159], a[212:215], v[228:231], v[144:159]
    buffer_load_dwordx4 v[44:47], v10, s[8:11], s43 offen offset:3072
    s_add_u32 s25, s25, 8192
    s_cmp_eq_u32 s25, 57344
    s_cselect_b32 s25, 0, s25
    s_waitcnt lgkmcnt(2)
    v_mfma_f32_32x32x16_bf16 v[128:143], a[216:219], v[160:163], v[128:143]
    v_mfma_f32_32x32x16_bf16 v[144:159], a[216:219], v[164:167], v[144:159]
    s_add_u32 s43, s52, s25
    buffer_load_dwordx4 v[48:51], v10, s[8:11], s43 offen offset:0
    s_waitcnt lgkmcnt(0)
    v_mfma_f32_32x32x16_bf16 v[128:143], a[220:223], v[168:171], v[128:143]
    v_mfma_f32_32x32x16_bf16 v[144:159], a[220:223], v[172:175], v[144:159]
    buffer_load_dwordx4 v[52:55], v10, s[8:11], s43 offen offset:1024
    v_mfma_f32_32x32x16_bf16 v[128:143], v[184:187], v[188:191], v[128:143]
    v_mfma_f32_32x32x16_bf16 v[144:159], v[184:187], v[192:195], v[144:159]
    v_add_u32 v2, 57600, v10
    s_mul_i32 s45, s39, 49
    s_add_u32 s45, s45, s40
    s_lshl_b32 s45, s45, 2
    s_add_u32 s45, s45, s36
    s_lshl_b32 s45, s45, 11
    s_add_u32 s44, s45, 8388608
    s_add_u32 s28, s40, 1
    s_cmp_eq_u32 s28, 7
    s_cselect_b32 s28, 0, s28
    s_mul_i32 s28, s28, 57344
    v_cvt_pk_bf16_f32 v200, v128, v129
    v_cvt_pk_bf16_f32 v201, v130, v131
    v_cvt_pk_bf16_f32 v202, v132, v133
    v_cvt_pk_bf16_f32 v203, v134, v135
    v_pk_max_i16 v200, v200, 0
    v_pk_max_i16 v201, v201, 0
    v_pk_max_i16 v202, v202, 0
    v_pk_max_i16 v203, v203, 0
    ds_write_b128 v212, v[200:203] offset:4096
    v_cvt_pk_bf16_f32 v204, v136, v137
    v_cvt_pk_bf16_f32 v205, v138, v139
    v_cvt_pk_bf16_f32 v206, v140, v141
    v_cvt_pk_bf16_f32 v207, v142, v143
    v_pk_max_i16 v204, v204, 0
    v_pk_max_i16 v205, v205, 0
    v_pk_max_i16 v206, v206, 0
    v_pk_max_i16 v207, v207, 0
    ds_write_b128 v212, v[204:207] offset:4608
    v_cvt_pk_bf16_f32 v200, v144, v145
    v_cvt_pk_bf16_f32 v201, v146, v147
    v_cvt_pk_bf16_f32 v202, v148, v149
    v_cvt_pk_bf16_f32 v203, v150, v151
    v_pk_max_i16 v200, v200, 0
    v_pk_max_i16 v201, v201, 0
    v_pk_max_i16 v202, v202, 0
    v_pk_max_i16 v203, v203, 0
    ds_write_b128 v212, v[200:203] offset:6144
    v_cvt_pk_bf16_f32 v204, v152, v153
    v_cvt_pk_bf16_f32 v205, v154, v155
    v_cvt_pk_bf16_f32 v206, v156, v157
    v_cvt_pk_bf16_f32 v207, v158, v159
    v_pk_max_i16 v204, v204, 0
    v_pk_max_i16 v205, v205, 0
    v_pk_max_i16 v206, v206, 0
    v_pk_max_i16 v207, v207, 0
    ds_write_b128 v212, v[204:207] offset:6656
    s_waitcnt lgkmcnt(0)
    s_barrier
    ds_read_b128 a[112:115], v2 offset:0
    ds_read_b128 a[116:119], v2 offset:1024
    ds_read_b128 a[120:123], v2 offset:2048
    ds_read_b128 a[124:127], v2 offset:3072
    ds_read_b128 a[128:131], v2 offset:4096
    ds_read_b128 a[132:135], v2 offset:5120
    ds_read_b128 a[136:139], v2 offset:6144
    ds_read_b128 a[140:143], v2 offset:7168
    v_add_u32 v3, s40, v1
    v_add_u32 v3, 1, v3
    v_cmp_le_u32 vcc, 7, v3
    v_subrev_u32 v4, 7, v3
    s_mul_i32 s45, s39, 7
    v_cndmask_b32 v3, v3, v4, vcc
    v_add_u32 v3, s45, v3
    v_lshlrev_b32 v3, 7, v3
    v_cmp_le_u32 vcc, 3, v1
    v_add_u32 v4, 4, v3
    v_mov_b32 v214, 1
    v_cndmask_b32 v213, v3, v4, vcc
    v_mov_b32 v215, 0
    s_add_u32 s45, s45, s40
    s_lshl_b32 s45, s45, 7
    s_add_u32 s54, s45, 6160384
    s_mov_b32 s55, 6160384
    s_waitcnt vmcnt(30) lgkmcnt(4)
    v_mfma_f32_16x16x32_bf16 v[96:99], a[0:3], a[112:115], 0
    ds_read_b128 a[144:147], v2 offset:8192
    buffer_load_dwordx4 v[56:59], v10, s[8:11], s43 offen offset:2048
    v_mfma_f32_16x16x32_bf16 v[100:103], a[0:3], a[116:119], 0
    ds_read_b128 a[148:151], v2 offset:9216
    v_mfma_f32_16x16x32_bf16 v[104:107], a[0:3], a[120:123], 0
    ds_read_b128 a[152:155], v2 offset:10240
    v_mfma_f32_16x16x32_bf16 v[108:111], a[0:3], a[124:127], 0
    ds_read_b128 a[156:159], v2 offset:11264
    s_waitcnt lgkmcnt(4)
    v_mfma_f32_16x16x32_bf16 v[96:99], a[4:7], a[128:131], v[96:99]
    ds_read_b128 a[160:163], v2 offset:12288
    buffer_load_dwordx4 v[60:63], v10, s[8:11], s43 offen offset:3072
    v_mfma_f32_16x16x32_bf16 v[100:103], a[4:7], a[132:135], v[100:103]
    ds_read_b128 a[164:167], v2 offset:13312
    v_mfma_f32_16x16x32_bf16 v[104:107], a[4:7], a[136:139], v[104:107]
    ds_read_b128 a[168:171], v2 offset:14336
    v_mfma_f32_16x16x32_bf16 v[108:111], a[4:7], a[140:143], v[108:111]
    ds_read_b128 a[172:175], v2 offset:15360
    s_waitcnt lgkmcnt(4)
    v_mfma_f32_16x16x32_bf16 v[96:99], a[8:11], a[144:147], v[96:99]
    ds_read_b128 a[176:179], v2 offset:16384
    s_add_u32 s43, s43, 4096
    buffer_load_dwordx4 v[64:67], v10, s[8:11], s43 offen offset:0
    v_mfma_f32_16x16x32_bf16 v[100:103], a[8:11], a[148:151], v[100:103]
    ds_read_b128 a[180:183], v2 offset:17408
    v_mfma_f32_16x16x32_bf16 v[104:107], a[8:11], a[152:155], v[104:107]
    ds_read_b128 a[184:187], v2 offset:18432
    v_mfma_f32_16x16x32_bf16 v[108:111], a[8:11], a[156:159], v[108:111]
    ds_read_b128 a[188:191], v2 offset:19456
    s_waitcnt lgkmcnt(4)
    v_mfma_f32_16x16x32_bf16 v[96:99], a[12:15], a[160:163], v[96:99]
    ds_read_b128 a[192:195], v2 offset:20480
    buffer_load_dwordx4 v[68:71], v10, s[8:11], s43 offen offset:1024
    v_mfma_f32_16x16x32_bf16 v[100:103], a[12:15], a[164:167], v[100:103]
    ds_read_b128 a[196:199], v2 offset:21504
    v_mfma_f32_16x16x32_bf16 v[104:107], a[12:15], a[168:171], v[104:107]
    ds_read_b128 a[200:203], v2 offset:22528
    v_mfma_f32_16x16x32_bf16 v[108:111], a[12:15], a[172:175], v[108:111]
    ds_read_b128 a[204:207], v2 offset:23552
    s_waitcnt vmcnt(30) lgkmcnt(4)
    v_mfma_f32_16x16x32_bf16 v[96:99], a[16:19], a[176:179], v[96:99]
    ds_read_b128 a[208:211], v2 offset:24576
    buffer_load_dwordx4 v[72:75], v10, s[8:11], s43 offen offset:2048
    v_mfma_f32_16x16x32_bf16 v[100:103], a[16:19], a[180:183], v[100:103]
    ds_read_b128 a[212:215], v2 offset:25600
    v_mfma_f32_16x16x32_bf16 v[104:107], a[16:19], a[184:187], v[104:107]
    ds_read_b128 a[216:219], v2 offset:26624
    v_mfma_f32_16x16x32_bf16 v[108:111], a[16:19], a[188:191], v[108:111]
    ds_read_b128 a[220:223], v2 offset:27648
    s_waitcnt lgkmcnt(4)
    v_mfma_f32_16x16x32_bf16 v[96:99], a[20:23], a[192:195], v[96:99]
    ds_read_b128 a[224:227], v2 offset:28672
    buffer_load_dwordx4 v[76:79], v10, s[8:11], s43 offen offset:3072
    s_add_u32 s25, s25, 8192
    s_cmp_eq_u32 s25, 57344
    s_cselect_b32 s25, 0, s25
    v_mfma_f32_16x16x32_bf16 v[100:103], a[20:23], a[196:199], v[100:103]
    ds_read_b128 a[228:231], v2 offset:29696
    v_mfma_f32_16x16x32_bf16 v[104:107], a[20:23], a[200:203], v[104:107]
    ds_read_b128 a[232:235], v2 offset:30720
    v_mfma_f32_16x16x32_bf16 v[108:111], a[20:23], a[204:207], v[108:111]
    ds_read_b128 a[236:239], v2 offset:31744
    s_waitcnt lgkmcnt(4)
    v_mfma_f32_16x16x32_bf16 v[96:99], a[24:27], a[208:211], v[96:99]
    s_add_u32 s43, s52, s25
    buffer_load_dwordx4 v[80:83], v10, s[8:11], s43 offen offset:0
    v_mfma_f32_16x16x32_bf16 v[100:103], a[24:27], a[212:215], v[100:103]
    v_mfma_f32_16x16x32_bf16 v[104:107], a[24:27], a[216:219], v[104:107]
    v_mfma_f32_16x16x32_bf16 v[108:111], a[24:27], a[220:223], v[108:111]
    s_waitcnt lgkmcnt(0)
    v_mfma_f32_16x16x32_bf16 v[96:99], a[28:31], a[224:227], v[96:99]
    buffer_load_dwordx4 v[84:87], v10, s[8:11], s43 offen offset:1024
    v_mfma_f32_16x16x32_bf16 v[100:103], a[28:31], a[228:231], v[100:103]
    v_mfma_f32_16x16x32_bf16 v[104:107], a[28:31], a[232:235], v[104:107]
    v_mfma_f32_16x16x32_bf16 v[108:111], a[28:31], a[236:239], v[108:111]
    s_waitcnt vmcnt(30)
    v_mfma_f32_16x16x32_bf16 v[112:115], a[32:35], a[112:115], 0
    buffer_load_dwordx4 v[88:91], v10, s[8:11], s43 offen offset:2048
    v_mfma_f32_16x16x32_bf16 v[116:119], a[32:35], a[116:119], 0
    v_mfma_f32_16x16x32_bf16 v[120:123], a[32:35], a[120:123], 0
    v_cvt_pk_bf16_f32 v128, v96, v97
    v_mfma_f32_16x16x32_bf16 v[124:127], a[32:35], a[124:127], 0
    v_cvt_pk_bf16_f32 v129, v100, v101
    v_mfma_f32_16x16x32_bf16 v[112:115], a[36:39], a[128:131], v[112:115]
    buffer_load_dwordx4 v[92:95], v10, s[8:11], s43 offen offset:3072
    v_mfma_f32_16x16x32_bf16 v[116:119], a[36:39], a[132:135], v[116:119]
    v_cvt_pk_bf16_f32 v130, v104, v105
    v_mfma_f32_16x16x32_bf16 v[120:123], a[36:39], a[136:139], v[120:123]
    v_cvt_pk_bf16_f32 v131, v108, v109
    v_mfma_f32_16x16x32_bf16 v[124:127], a[36:39], a[140:143], v[124:127]
    s_add_u32 s53, s44, s28
    v_mfma_f32_16x16x32_bf16 v[112:115], a[40:43], a[144:147], v[112:115]
    s_add_u32 s43, s43, 4096
    buffer_load_dwordx4 a[0:3], v10, s[8:11], s43 offen offset:0
    v_mfma_f32_16x16x32_bf16 v[116:119], a[40:43], a[148:151], v[116:119]
    buffer_store_dwordx4 v[128:131], v10, s[8:11], s53 offen offset:0 sc1
    v_mfma_f32_16x16x32_bf16 v[120:123], a[40:43], a[152:155], v[120:123]
    v_cvt_pk_bf16_f32 v132, v98, v99
    v_mfma_f32_16x16x32_bf16 v[124:127], a[40:43], a[156:159], v[124:127]
    v_cvt_pk_bf16_f32 v133, v102, v103
    v_mfma_f32_16x16x32_bf16 v[112:115], a[44:47], a[160:163], v[112:115]
    buffer_load_dwordx4 a[4:7], v10, s[8:11], s43 offen offset:1024
    v_mfma_f32_16x16x32_bf16 v[116:119], a[44:47], a[164:167], v[116:119]
    v_cvt_pk_bf16_f32 v134, v106, v107
    v_mfma_f32_16x16x32_bf16 v[120:123], a[44:47], a[168:171], v[120:123]
    v_cvt_pk_bf16_f32 v135, v110, v111
    v_mfma_f32_16x16x32_bf16 v[124:127], a[44:47], a[172:175], v[124:127]
    buffer_store_dwordx4 v[132:135], v10, s[8:11], s53 offen offset:1024 sc1
    s_waitcnt vmcnt(32)
    v_mfma_f32_16x16x32_bf16 v[112:115], a[48:51], a[176:179], v[112:115]
    buffer_load_dwordx4 a[8:11], v10, s[8:11], s43 offen offset:2048
    v_mfma_f32_16x16x32_bf16 v[116:119], a[48:51], a[180:183], v[116:119]
    s_add_u32 s28, s28, 57344
    s_cmp_eq_u32 s28, 401408
    s_cselect_b32 s28, 0, s28
    v_mfma_f32_16x16x32_bf16 v[120:123], a[48:51], a[184:187], v[120:123]
    v_mfma_f32_16x16x32_bf16 v[124:127], a[48:51], a[188:191], v[124:127]
    v_mfma_f32_16x16x32_bf16 v[112:115], a[52:55], a[192:195], v[112:115]
    buffer_load_dwordx4 a[12:15], v10, s[8:11], s43 offen offset:3072
    s_add_u32 s25, s25, 8192
    s_cmp_eq_u32 s25, 57344
    s_cselect_b32 s25, 0, s25
    v_mfma_f32_16x16x32_bf16 v[116:119], a[52:55], a[196:199], v[116:119]
    v_mfma_f32_16x16x32_bf16 v[120:123], a[52:55], a[200:203], v[120:123]
    v_mfma_f32_16x16x32_bf16 v[124:127], a[52:55], a[204:207], v[124:127]
    v_mfma_f32_16x16x32_bf16 v[112:115], a[56:59], a[208:211], v[112:115]
    s_add_u32 s43, s52, s25
    buffer_load_dwordx4 a[16:19], v10, s[8:11], s43 offen offset:0
    v_mfma_f32_16x16x32_bf16 v[116:119], a[56:59], a[212:215], v[116:119]
    v_mfma_f32_16x16x32_bf16 v[120:123], a[56:59], a[216:219], v[120:123]
    v_mfma_f32_16x16x32_bf16 v[124:127], a[56:59], a[220:223], v[124:127]
    v_mfma_f32_16x16x32_bf16 v[112:115], a[60:63], a[224:227], v[112:115]
    buffer_load_dwordx4 a[20:23], v10, s[8:11], s43 offen offset:1024
    v_mfma_f32_16x16x32_bf16 v[116:119], a[60:63], a[228:231], v[116:119]
    v_mfma_f32_16x16x32_bf16 v[120:123], a[60:63], a[232:235], v[120:123]
    v_mfma_f32_16x16x32_bf16 v[124:127], a[60:63], a[236:239], v[124:127]
    s_waitcnt vmcnt(32)
    v_mfma_f32_16x16x32_bf16 v[96:99], a[64:67], a[112:115], 0
    buffer_load_dwordx4 a[24:27], v10, s[8:11], s43 offen offset:2048
    v_mfma_f32_16x16x32_bf16 v[100:103], a[64:67], a[116:119], 0
    v_mfma_f32_16x16x32_bf16 v[104:107], a[64:67], a[120:123], 0
    v_cvt_pk_bf16_f32 v136, v112, v113
    v_mfma_f32_16x16x32_bf16 v[108:111], a[64:67], a[124:127], 0
    v_cvt_pk_bf16_f32 v137, v116, v117
    v_mfma_f32_16x16x32_bf16 v[96:99], a[68:71], a[128:131], v[96:99]
    buffer_load_dwordx4 a[28:31], v10, s[8:11], s43 offen offset:3072
    v_mfma_f32_16x16x32_bf16 v[100:103], a[68:71], a[132:135], v[100:103]
    v_cvt_pk_bf16_f32 v138, v120, v121
    v_mfma_f32_16x16x32_bf16 v[104:107], a[68:71], a[136:139], v[104:107]
    v_cvt_pk_bf16_f32 v139, v124, v125
    v_mfma_f32_16x16x32_bf16 v[108:111], a[68:71], a[140:143], v[108:111]
    s_add_u32 s53, s44, s28
    v_mfma_f32_16x16x32_bf16 v[96:99], a[72:75], a[144:147], v[96:99]
    s_add_u32 s43, s43, 4096
    buffer_load_dwordx4 a[32:35], v10, s[8:11], s43 offen offset:0
    v_mfma_f32_16x16x32_bf16 v[100:103], a[72:75], a[148:151], v[100:103]
    buffer_store_dwordx4 v[136:139], v10, s[8:11], s53 offen offset:0 sc1
    v_mfma_f32_16x16x32_bf16 v[104:107], a[72:75], a[152:155], v[104:107]
    v_cvt_pk_bf16_f32 v140, v114, v115
    v_mfma_f32_16x16x32_bf16 v[108:111], a[72:75], a[156:159], v[108:111]
    v_cvt_pk_bf16_f32 v141, v118, v119
    v_mfma_f32_16x16x32_bf16 v[96:99], a[76:79], a[160:163], v[96:99]
    buffer_load_dwordx4 a[36:39], v10, s[8:11], s43 offen offset:1024
    v_mfma_f32_16x16x32_bf16 v[100:103], a[76:79], a[164:167], v[100:103]
    v_cvt_pk_bf16_f32 v142, v122, v123
    v_mfma_f32_16x16x32_bf16 v[104:107], a[76:79], a[168:171], v[104:107]
    v_cvt_pk_bf16_f32 v143, v126, v127
    v_mfma_f32_16x16x32_bf16 v[108:111], a[76:79], a[172:175], v[108:111]
    buffer_store_dwordx4 v[140:143], v10, s[8:11], s53 offen offset:1024 sc1
    s_waitcnt vmcnt(34)
    v_mfma_f32_16x16x32_bf16 v[96:99], a[80:83], a[176:179], v[96:99]
    buffer_load_dwordx4 a[40:43], v10, s[8:11], s43 offen offset:2048
    v_mfma_f32_16x16x32_bf16 v[100:103], a[80:83], a[180:183], v[100:103]
    s_add_u32 s28, s28, 57344
    s_cmp_eq_u32 s28, 401408
    s_cselect_b32 s28, 0, s28
    v_mfma_f32_16x16x32_bf16 v[104:107], a[80:83], a[184:187], v[104:107]
    v_mfma_f32_16x16x32_bf16 v[108:111], a[80:83], a[188:191], v[108:111]
    v_mfma_f32_16x16x32_bf16 v[96:99], a[84:87], a[192:195], v[96:99]
    buffer_load_dwordx4 a[44:47], v10, s[8:11], s43 offen offset:3072
    v_mfma_f32_16x16x32_bf16 v[100:103], a[84:87], a[196:199], v[100:103]
    v_mfma_f32_16x16x32_bf16 v[104:107], a[84:87], a[200:203], v[104:107]
    v_mfma_f32_16x16x32_bf16 v[108:111], a[84:87], a[204:207], v[108:111]
    v_mfma_f32_16x16x32_bf16 v[96:99], a[88:91], a[208:211], v[96:99]
    v_mfma_f32_16x16x32_bf16 v[100:103], a[88:91], a[212:215], v[100:103]
    v_mfma_f32_16x16x32_bf16 v[104:107], a[88:91], a[216:219], v[104:107]
    v_mfma_f32_16x16x32_bf16 v[108:111], a[88:91], a[220:223], v[108:111]
    v_mfma_f32_16x16x32_bf16 v[96:99], a[92:95], a[224:227], v[96:99]
    v_mfma_f32_16x16x32_bf16 v[100:103], a[92:95], a[228:231], v[100:103]
    v_mfma_f32_16x16x32_bf16 v[104:107], a[92:95], a[232:235], v[104:107]
    v_mfma_f32_16x16x32_bf16 v[108:111], a[92:95], a[236:239], v[108:111]
    s_waitcnt vmcnt(32)
    v_mfma_f32_16x16x32_bf16 v[112:115], a[96:99], a[112:115], 0
    v_mfma_f32_16x16x32_bf16 v[116:119], a[96:99], a[116:119], 0
    v_mfma_f32_16x16x32_bf16 v[120:123], a[96:99], a[120:123], 0
s_nop 0
    v_cvt_pk_bf16_f32 v128, v96, v97
    v_mfma_f32_16x16x32_bf16 v[124:127], a[96:99], a[124:127], 0
    v_cvt_pk_bf16_f32 v129, v100, v101
    v_mfma_f32_16x16x32_bf16 v[112:115], a[100:103], a[128:131], v[112:115]
    v_mfma_f32_16x16x32_bf16 v[116:119], a[100:103], a[132:135], v[116:119]
    v_cvt_pk_bf16_f32 v130, v104, v105
    v_mfma_f32_16x16x32_bf16 v[120:123], a[100:103], a[136:139], v[120:123]
    v_cvt_pk_bf16_f32 v131, v108, v109
    v_mfma_f32_16x16x32_bf16 v[124:127], a[100:103], a[140:143], v[124:127]
    s_add_u32 s53, s44, s28
    v_mfma_f32_16x16x32_bf16 v[112:115], a[104:107], a[144:147], v[112:115]
    v_mfma_f32_16x16x32_bf16 v[116:119], a[104:107], a[148:151], v[116:119]
    buffer_store_dwordx4 v[128:131], v10, s[8:11], s53 offen offset:0 sc1
    v_mfma_f32_16x16x32_bf16 v[120:123], a[104:107], a[152:155], v[120:123]
    v_cvt_pk_bf16_f32 v132, v98, v99
    v_mfma_f32_16x16x32_bf16 v[124:127], a[104:107], a[156:159], v[124:127]
    v_cvt_pk_bf16_f32 v133, v102, v103
    v_mfma_f32_16x16x32_bf16 v[112:115], a[108:111], a[160:163], v[112:115]
    v_mfma_f32_16x16x32_bf16 v[116:119], a[108:111], a[164:167], v[116:119]
    v_cvt_pk_bf16_f32 v134, v106, v107
    v_mfma_f32_16x16x32_bf16 v[120:123], a[108:111], a[168:171], v[120:123]
    v_cvt_pk_bf16_f32 v135, v110, v111
    v_mfma_f32_16x16x32_bf16 v[124:127], a[108:111], a[172:175], v[124:127]
    buffer_store_dwordx4 v[132:135], v10, s[8:11], s53 offen offset:1024 sc1
    s_waitcnt vmcnt(30)
    v_mfma_f32_16x16x32_bf16 v[112:115], v[32:35], a[176:179], v[112:115]
    v_mfma_f32_16x16x32_bf16 v[116:119], v[32:35], a[180:183], v[116:119]
    s_add_u32 s28, s28, 57344
    s_cmp_eq_u32 s28, 401408
    s_cselect_b32 s28, 0, s28
    v_mfma_f32_16x16x32_bf16 v[120:123], v[32:35], a[184:187], v[120:123]
    v_mfma_f32_16x16x32_bf16 v[124:127], v[32:35], a[188:191], v[124:127]
    v_mfma_f32_16x16x32_bf16 v[112:115], v[36:39], a[192:195], v[112:115]
    v_mfma_f32_16x16x32_bf16 v[116:119], v[36:39], a[196:199], v[116:119]
    v_mfma_f32_16x16x32_bf16 v[120:123], v[36:39], a[200:203], v[120:123]
    v_mfma_f32_16x16x32_bf16 v[124:127], v[36:39], a[204:207], v[124:127]
    v_mfma_f32_16x16x32_bf16 v[112:115], v[40:43], a[208:211], v[112:115]
    v_mfma_f32_16x16x32_bf16 v[116:119], v[40:43], a[212:215], v[116:119]
    v_mfma_f32_16x16x32_bf16 v[120:123], v[40:43], a[216:219], v[120:123]
    v_mfma_f32_16x16x32_bf16 v[124:127], v[40:43], a[220:223], v[124:127]
    v_mfma_f32_16x16x32_bf16 v[112:115], v[44:47], a[224:227], v[112:115]
    v_mfma_f32_16x16x32_bf16 v[116:119], v[44:47], a[228:231], v[116:119]
    v_mfma_f32_16x16x32_bf16 v[120:123], v[44:47], a[232:235], v[120:123]
    v_mfma_f32_16x16x32_bf16 v[124:127], v[44:47], a[236:239], v[124:127]
    s_waitcnt vmcnt(26)
    v_mfma_f32_16x16x32_bf16 v[96:99], v[48:51], a[112:115], 0
    v_mfma_f32_16x16x32_bf16 v[100:103], v[48:51], a[116:119], 0
    v_mfma_f32_16x16x32_bf16 v[104:107], v[48:51], a[120:123], 0
s_nop 0
    v_cvt_pk_bf16_f32 v136, v112, v113
    v_mfma_f32_16x16x32_bf16 v[108:111], v[48:51], a[124:127], 0
    v_cvt_pk_bf16_f32 v137, v116, v117
    v_mfma_f32_16x16x32_bf16 v[96:99], v[52:55], a[128:131], v[96:99]
    v_mfma_f32_16x16x32_bf16 v[100:103], v[52:55], a[132:135], v[100:103]
    v_cvt_pk_bf16_f32 v138, v120, v121
    v_mfma_f32_16x16x32_bf16 v[104:107], v[52:55], a[136:139], v[104:107]
    v_cvt_pk_bf16_f32 v139, v124, v125
    v_mfma_f32_16x16x32_bf16 v[108:111], v[52:55], a[140:143], v[108:111]
    s_add_u32 s53, s44, s28
    v_mfma_f32_16x16x32_bf16 v[96:99], v[56:59], a[144:147], v[96:99]
    v_mfma_f32_16x16x32_bf16 v[100:103], v[56:59], a[148:151], v[100:103]
    buffer_store_dwordx4 v[136:139], v10, s[8:11], s53 offen offset:0 sc1
    v_mfma_f32_16x16x32_bf16 v[104:107], v[56:59], a[152:155], v[104:107]
    v_cvt_pk_bf16_f32 v140, v114, v115
    v_mfma_f32_16x16x32_bf16 v[108:111], v[56:59], a[156:159], v[108:111]
    v_cvt_pk_bf16_f32 v141, v118, v119
    v_mfma_f32_16x16x32_bf16 v[96:99], v[60:63], a[160:163], v[96:99]
    v_mfma_f32_16x16x32_bf16 v[100:103], v[60:63], a[164:167], v[100:103]
    v_cvt_pk_bf16_f32 v142, v122, v123
    v_mfma_f32_16x16x32_bf16 v[104:107], v[60:63], a[168:171], v[104:107]
    v_cvt_pk_bf16_f32 v143, v126, v127
    v_mfma_f32_16x16x32_bf16 v[108:111], v[60:63], a[172:175], v[108:111]
    buffer_store_dwordx4 v[140:143], v10, s[8:11], s53 offen offset:1024 sc1
    s_waitcnt vmcnt(24)
    v_mfma_f32_16x16x32_bf16 v[96:99], v[64:67], a[176:179], v[96:99]
    v_mfma_f32_16x16x32_bf16 v[100:103], v[64:67], a[180:183], v[100:103]
    s_add_u32 s28, s28, 57344
    s_cmp_eq_u32 s28, 401408
    s_cselect_b32 s28, 0, s28
    v_mfma_f32_16x16x32_bf16 v[104:107], v[64:67], a[184:187], v[104:107]
    v_mfma_f32_16x16x32_bf16 v[108:111], v[64:67], a[188:191], v[108:111]
    v_mfma_f32_16x16x32_bf16 v[96:99], v[68:71], a[192:195], v[96:99]
    v_mfma_f32_16x16x32_bf16 v[100:103], v[68:71], a[196:199], v[100:103]
    v_mfma_f32_16x16x32_bf16 v[104:107], v[68:71], a[200:203], v[104:107]
    v_mfma_f32_16x16x32_bf16 v[108:111], v[68:71], a[204:207], v[108:111]
    v_mfma_f32_16x16x32_bf16 v[96:99], v[72:75], a[208:211], v[96:99]
    v_mfma_f32_16x16x32_bf16 v[100:103], v[72:75], a[212:215], v[100:103]
    v_mfma_f32_16x16x32_bf16 v[104:107], v[72:75], a[216:219], v[104:107]
    v_mfma_f32_16x16x32_bf16 v[108:111], v[72:75], a[220:223], v[108:111]
    v_mfma_f32_16x16x32_bf16 v[96:99], v[76:79], a[224:227], v[96:99]
    v_mfma_f32_16x16x32_bf16 v[100:103], v[76:79], a[228:231], v[100:103]
    v_mfma_f32_16x16x32_bf16 v[104:107], v[76:79], a[232:235], v[104:107]
    v_mfma_f32_16x16x32_bf16 v[108:111], v[76:79], a[236:239], v[108:111]
    s_waitcnt vmcnt(20)
    v_mfma_f32_16x16x32_bf16 v[112:115], v[80:83], a[112:115], 0
    v_mfma_f32_16x16x32_bf16 v[116:119], v[80:83], a[116:119], 0
    v_mfma_f32_16x16x32_bf16 v[120:123], v[80:83], a[120:123], 0
s_nop 0
    v_cvt_pk_bf16_f32 v128, v96, v97
    v_mfma_f32_16x16x32_bf16 v[124:127], v[80:83], a[124:127], 0
    v_cvt_pk_bf16_f32 v129, v100, v101
    v_mfma_f32_16x16x32_bf16 v[112:115], v[84:87], a[128:131], v[112:115]
    v_mfma_f32_16x16x32_bf16 v[116:119], v[84:87], a[132:135], v[116:119]
    v_cvt_pk_bf16_f32 v130, v104, v105
    v_mfma_f32_16x16x32_bf16 v[120:123], v[84:87], a[136:139], v[120:123]
    v_cvt_pk_bf16_f32 v131, v108, v109
    v_mfma_f32_16x16x32_bf16 v[124:127], v[84:87], a[140:143], v[124:127]
    s_add_u32 s53, s44, s28
    v_mfma_f32_16x16x32_bf16 v[112:115], v[88:91], a[144:147], v[112:115]
    v_mfma_f32_16x16x32_bf16 v[116:119], v[88:91], a[148:151], v[116:119]
    buffer_store_dwordx4 v[128:131], v10, s[8:11], s53 offen offset:0 sc1
    v_mfma_f32_16x16x32_bf16 v[120:123], v[88:91], a[152:155], v[120:123]
    v_cvt_pk_bf16_f32 v132, v98, v99
    v_mfma_f32_16x16x32_bf16 v[124:127], v[88:91], a[156:159], v[124:127]
    v_cvt_pk_bf16_f32 v133, v102, v103
    v_mfma_f32_16x16x32_bf16 v[112:115], v[92:95], a[160:163], v[112:115]
    v_mfma_f32_16x16x32_bf16 v[116:119], v[92:95], a[164:167], v[116:119]
    v_cvt_pk_bf16_f32 v134, v106, v107
    v_mfma_f32_16x16x32_bf16 v[120:123], v[92:95], a[168:171], v[120:123]
    v_cvt_pk_bf16_f32 v135, v110, v111
    v_mfma_f32_16x16x32_bf16 v[124:127], v[92:95], a[172:175], v[124:127]
    buffer_store_dwordx4 v[132:135], v10, s[8:11], s53 offen offset:1024 sc1
    s_waitcnt vmcnt(16)
    v_mfma_f32_16x16x32_bf16 v[112:115], a[0:3], a[176:179], v[112:115]
    v_mfma_f32_16x16x32_bf16 v[116:119], a[0:3], a[180:183], v[116:119]
    s_add_u32 s28, s28, 57344
    s_cmp_eq_u32 s28, 401408
    s_cselect_b32 s28, 0, s28
    v_mfma_f32_16x16x32_bf16 v[120:123], a[0:3], a[184:187], v[120:123]
    v_mfma_f32_16x16x32_bf16 v[124:127], a[0:3], a[188:191], v[124:127]
    s_waitcnt vmcnt(4)
    s_mov_b64 exec, 7
    buffer_atomic_add v214, v213, s[8:11], s55 offen sc1
    s_mov_b64 exec, -1
    v_mfma_f32_16x16x32_bf16 v[112:115], a[4:7], a[192:195], v[112:115]
    v_mfma_f32_16x16x32_bf16 v[116:119], a[4:7], a[196:199], v[116:119]
    v_mfma_f32_16x16x32_bf16 v[120:123], a[4:7], a[200:203], v[120:123]
    v_mfma_f32_16x16x32_bf16 v[124:127], a[4:7], a[204:207], v[124:127]
    v_mfma_f32_16x16x32_bf16 v[112:115], a[8:11], a[208:211], v[112:115]
    v_mfma_f32_16x16x32_bf16 v[116:119], a[8:11], a[212:215], v[116:119]
    v_mfma_f32_16x16x32_bf16 v[120:123], a[8:11], a[216:219], v[120:123]
    v_mfma_f32_16x16x32_bf16 v[124:127], a[8:11], a[220:223], v[124:127]
    v_mfma_f32_16x16x32_bf16 v[112:115], a[12:15], a[224:227], v[112:115]
    v_mfma_f32_16x16x32_bf16 v[116:119], a[12:15], a[228:231], v[116:119]
    v_mfma_f32_16x16x32_bf16 v[120:123], a[12:15], a[232:235], v[120:123]
    v_mfma_f32_16x16x32_bf16 v[124:127], a[12:15], a[236:239], v[124:127]
    v_mfma_f32_16x16x32_bf16 v[96:99], a[16:19], a[112:115], 0
    v_mfma_f32_16x16x32_bf16 v[100:103], a[16:19], a[116:119], 0
    v_mfma_f32_16x16x32_bf16 v[104:107], a[16:19], a[120:123], 0
s_nop 1
    v_cvt_pk_bf16_f32 v136, v112, v113
    v_mfma_f32_16x16x32_bf16 v[108:111], a[16:19], a[124:127], 0
    v_cvt_pk_bf16_f32 v137, v116, v117
    v_mfma_f32_16x16x32_bf16 v[96:99], a[20:23], a[128:131], v[96:99]
    v_mfma_f32_16x16x32_bf16 v[100:103], a[20:23], a[132:135], v[100:103]
    v_cvt_pk_bf16_f32 v138, v120, v121
    v_mfma_f32_16x16x32_bf16 v[104:107], a[20:23], a[136:139], v[104:107]
    v_cvt_pk_bf16_f32 v139, v124, v125
    v_mfma_f32_16x16x32_bf16 v[108:111], a[20:23], a[140:143], v[108:111]
    s_add_u32 s53, s44, s28
    v_mfma_f32_16x16x32_bf16 v[96:99], a[24:27], a[144:147], v[96:99]
    v_mfma_f32_16x16x32_bf16 v[100:103], a[24:27], a[148:151], v[100:103]
    buffer_store_dwordx4 v[136:139], v10, s[8:11], s53 offen offset:0 sc1
    v_mfma_f32_16x16x32_bf16 v[104:107], a[24:27], a[152:155], v[104:107]
    v_cvt_pk_bf16_f32 v140, v114, v115
    v_mfma_f32_16x16x32_bf16 v[108:111], a[24:27], a[156:159], v[108:111]
    v_cvt_pk_bf16_f32 v141, v118, v119
    v_mfma_f32_16x16x32_bf16 v[96:99], a[28:31], a[160:163], v[96:99]
    v_mfma_f32_16x16x32_bf16 v[100:103], a[28:31], a[164:167], v[100:103]
    v_cvt_pk_bf16_f32 v142, v122, v123
    v_mfma_f32_16x16x32_bf16 v[104:107], a[28:31], a[168:171], v[104:107]
    v_cvt_pk_bf16_f32 v143, v126, v127
    v_mfma_f32_16x16x32_bf16 v[108:111], a[28:31], a[172:175], v[108:111]
    buffer_store_dwordx4 v[140:143], v10, s[8:11], s53 offen offset:1024 sc1
    v_mfma_f32_16x16x32_bf16 v[96:99], a[32:35], a[176:179], v[96:99]
    v_mfma_f32_16x16x32_bf16 v[100:103], a[32:35], a[180:183], v[100:103]
    s_add_u32 s28, s28, 57344
    s_cmp_eq_u32 s28, 401408
    s_cselect_b32 s28, 0, s28
    v_mfma_f32_16x16x32_bf16 v[104:107], a[32:35], a[184:187], v[104:107]
    v_mfma_f32_16x16x32_bf16 v[108:111], a[32:35], a[188:191], v[108:111]
    v_mfma_f32_16x16x32_bf16 v[96:99], a[36:39], a[192:195], v[96:99]
    v_mfma_f32_16x16x32_bf16 v[100:103], a[36:39], a[196:199], v[100:103]
    v_mfma_f32_16x16x32_bf16 v[104:107], a[36:39], a[200:203], v[104:107]
    v_mfma_f32_16x16x32_bf16 v[108:111], a[36:39], a[204:207], v[108:111]
    v_mfma_f32_16x16x32_bf16 v[96:99], a[40:43], a[208:211], v[96:99]
    v_mfma_f32_16x16x32_bf16 v[100:103], a[40:43], a[212:215], v[100:103]
    v_mfma_f32_16x16x32_bf16 v[104:107], a[40:43], a[216:219], v[104:107]
    v_mfma_f32_16x16x32_bf16 v[108:111], a[40:43], a[220:223], v[108:111]
    v_mfma_f32_16x16x32_bf16 v[96:99], a[44:47], a[224:227], v[96:99]
    v_mfma_f32_16x16x32_bf16 v[100:103], a[44:47], a[228:231], v[100:103]
    v_mfma_f32_16x16x32_bf16 v[104:107], a[44:47], a[232:235], v[104:107]
    v_mfma_f32_16x16x32_bf16 v[108:111], a[44:47], a[236:239], v[108:111]
    s_waitcnt vmcnt(0)
    s_mov_b64 exec, 56
    buffer_atomic_add v214, v213, s[8:11], s55 offen sc1
    s_mov_b64 exec, -1
    v_mov_b32 v208, 0x3f80
    v_mov_b32 v209, 0x3f800000
    s_mul_i32 s45, s39, 49
    s_mul_i32 s46, s40, 7
    s_add_u32 s45, s45, s46
    s_lshl_b32 s45, s45, 2
    s_add_u32 s45, s45, s36
    s_lshl_b32 s45, s45, 11
    s_add_u32 s45, s45, 8388608
    s_cmp_eq_u32 s40, 0
    s_cselect_b32 s46, 7, s40
    s_sub_u32 s46, s46, 1
    v_and_b32 v2, 15, v1
    s_lshl_b32 s47, s36, 4
    v_add_u32 v3, s47, v2
    v_lshrrev_b32 v4, 3, v3
    v_lshlrev_b32 v4, 10, v4
    v_and_b32 v5, 7, v3
    v_lshl_add_u32 v4, v5, 7, v4
    v_bfe_u32 v5, v3, 1, 3
    v_lshrrev_b32 v6, 4, v1
    v_xor_b32 v5, v5, v6
    v_lshl_add_u32 v4, v5, 4, v4
    v_xor_b32 v5, 64, v4
    ds_read_b128 v[32:35], v4 offset:0
    ds_read_b128 v[36:39], v5 offset:0
    ds_read_b128 v[40:43], v4 offset:8192
    ds_read_b128 v[44:47], v5 offset:8192
    ds_read_b128 v[48:51], v4 offset:16384
    ds_read_b128 v[52:55], v5 offset:16384
    ds_read_b128 v[56:59], v4 offset:24576
    ds_read_b128 v[60:63], v5 offset:24576
    ds_read_b128 v[64:67], v4 offset:32768
    ds_read_b128 v[68:71], v5 offset:32768
    ds_read_b128 v[72:75], v4 offset:40960
    ds_read_b128 v[76:79], v5 offset:40960
    ds_read_b128 v[80:83], v4 offset:49152
    ds_read_b128 v[84:87], v5 offset:49152
    v_lshlrev_b32 v3, 2, v3
    v_add_u32 v3, 123136, v3
    v_mov_b32 v8, 0
    v_mov_b32 v9, 0
    s_waitcnt lgkmcnt(13)
    v_dot2c_f32_bf16 v8, v32, v32
    v_dot2c_f32_bf16 v9, v33, v33
    v_dot2c_f32_bf16 v8, v34, v34
    v_dot2c_f32_bf16 v9, v35, v35
    s_waitcnt lgkmcnt(12)
    v_dot2c_f32_bf16 v8, v36, v36
    v_dot2c_f32_bf16 v9, v37, v37
    v_dot2c_f32_bf16 v8, v38, v38
    v_dot2c_f32_bf16 v9, v39, v39
    s_waitcnt lgkmcnt(11)
    v_dot2c_f32_bf16 v8, v40, v40
    v_dot2c_f32_bf16 v9, v41, v41
    v_dot2c_f32_bf16 v8, v42, v42
    v_dot2c_f32_bf16 v9, v43, v43
    s_waitcnt lgkmcnt(10)
    v_dot2c_f32_bf16 v8, v44, v44
    v_dot2c_f32_bf16 v9, v45, v45
    v_dot2c_f32_bf16 v8, v46, v46
    v_dot2c_f32_bf16 v9, v47, v47
    s_waitcnt lgkmcnt(9)
    v_dot2c_f32_bf16 v8, v48, v48
    v_dot2c_f32_bf16 v9, v49, v49
    v_dot2c_f32_bf16 v8, v50, v50
    v_dot2c_f32_bf16 v9, v51, v51
    s_waitcnt lgkmcnt(8)
    v_dot2c_f32_bf16 v8, v52, v52
    v_dot2c_f32_bf16 v9, v53, v53
    v_dot2c_f32_bf16 v8, v54, v54
    v_dot2c_f32_bf16 v9, v55, v55
    s_waitcnt lgkmcnt(7)
    v_dot2c_f32_bf16 v8, v56, v56
    v_dot2c_f32_bf16 v9, v57, v57
    v_dot2c_f32_bf16 v8, v58, v58
    v_dot2c_f32_bf16 v9, v59, v59
    s_waitcnt lgkmcnt(6)
    v_dot2c_f32_bf16 v8, v60, v60
    v_dot2c_f32_bf16 v9, v61, v61
    v_dot2c_f32_bf16 v8, v62, v62
    v_dot2c_f32_bf16 v9, v63, v63
    s_waitcnt lgkmcnt(5)
    v_dot2c_f32_bf16 v8, v64, v64
    v_dot2c_f32_bf16 v9, v65, v65
    v_dot2c_f32_bf16 v8, v66, v66
    v_dot2c_f32_bf16 v9, v67, v67
    s_waitcnt lgkmcnt(4)
    v_dot2c_f32_bf16 v8, v68, v68
    v_dot2c_f32_bf16 v9, v69, v69
    v_dot2c_f32_bf16 v8, v70, v70
    v_dot2c_f32_bf16 v9, v71, v71
    s_waitcnt lgkmcnt(3)
    v_dot2c_f32_bf16 v8, v72, v72
    v_dot2c_f32_bf16 v9, v73, v73
    v_dot2c_f32_bf16 v8, v74, v74
    v_dot2c_f32_bf16 v9, v75, v75
    s_waitcnt lgkmcnt(2)
    v_dot2c_f32_bf16 v8, v76, v76
    v_dot2c_f32_bf16 v9, v77, v77
    v_dot2c_f32_bf16 v8, v78, v78
    v_dot2c_f32_bf16 v9, v79, v79
    s_waitcnt lgkmcnt(1)
    v_dot2c_f32_bf16 v8, v80, v80
    v_dot2c_f32_bf16 v9, v81, v81
    v_dot2c_f32_bf16 v8, v82, v82
    v_dot2c_f32_bf16 v9, v83, v83
    s_waitcnt lgkmcnt(0)
    v_dot2c_f32_bf16 v8, v84, v84
    v_dot2c_f32_bf16 v9, v85, v85
    v_dot2c_f32_bf16 v8, v86, v86
    v_dot2c_f32_bf16 v9, v87, v87
    ds_read_b32 v6, v3
    ds_read_b32 v7, v3 offset:256
s_nop 0
    v_add_f32 v8, v8, v9
    v_mov_b32 v9, v8
s_nop 1
    v_permlane16_swap_b32 v8, v9
    v_add_f32 v8, v8, v9
    v_mov_b32 v9, v8
s_nop 1
    v_permlane32_swap_b32 v8, v9
    v_add_f32 v8, v8, v9
    s_waitcnt lgkmcnt(0)
    v_add_f32 v6, v6, v7
    v_mul_f32 v6, 0x3b124925, v6
    v_mul_f32 v8, 0x3b124925, v8
    v_fma_f32 v8, -v6, v6, v8
    v_add_f32 v8, 0x3727c5ac, v8
    v_rsq_f32 v210, v8
    s_cmp_lg_u32 s36, 0
    s_cbranch_scc1 L_k2_others
    s_mov_b32 s56, 0
    s_mov_b32 s57, 0
L_k2_poll:
    buffer_load_dwordx2 v[176:177], v215, s[8:11], s54 offen sc1
L_k2_chk:
    s_waitcnt vmcnt(0)
    v_readfirstlane_b32 s58, v176
    v_readfirstlane_b32 s59, v177
    s_cmp_lg_u32 s56, 0
    s_cbranch_scc1 L_k2_p2_0
    s_cmp_lt_u32 s58, 12
    s_cbranch_scc1 L_k2_pn_0
    buffer_load_dwordx2 v[178:179], v215, s[8:11], s54 offen sc1
    s_barrier
    s_mov_b32 s56, 1
    s_cmp_ge_u32 s59, 12
    s_cbranch_scc1 L_k2_pdone
    s_waitcnt vmcnt(0)
    v_readfirstlane_b32 s59, v179
L_k2_p2_0:
s_nop 0
    s_cmp_ge_u32 s59, 12
    s_cbranch_scc1 L_k2_pdone
L_k2_pn_0:
    s_add_u32 s57, s57, 1
    s_cmp_lt_u32 s57, 0x4000
    s_cbranch_scc1 L_k2_poll
    s_cmp_lg_u32 s56, 0
    s_cbranch_scc1 L_k2_pdone
    s_barrier
L_k2_pdone:
    s_barrier
    s_lshl_b32 s47, s46, 13
    s_add_u32 s47, s47, s45
    buffer_load_dwordx4 v[128:131], v10, s[8:11], s47 offen sc1
    buffer_load_dwordx4 v[132:135], v10, s[8:11], s47 offen offset:1024 sc1
    s_cmp_eq_u32 s46, 0
    s_cselect_b32 s46, 7, s46
    s_sub_u32 s46, s46, 1
    s_lshl_b32 s47, s46, 13
    s_add_u32 s47, s47, s45
    buffer_load_dwordx4 v[136:139], v10, s[8:11], s47 offen sc1
    buffer_load_dwordx4 v[140:143], v10, s[8:11], s47 offen offset:1024 sc1
    s_cmp_eq_u32 s46, 0
    s_cselect_b32 s46, 7, s46
    s_sub_u32 s46, s46, 1
    s_lshl_b32 s47, s46, 13
    s_add_u32 s47, s47, s45
    buffer_load_dwordx4 v[144:147], v10, s[8:11], s47 offen sc1
    buffer_load_dwordx4 v[148:151], v10, s[8:11], s47 offen offset:1024 sc1
    s_cmp_eq_u32 s46, 0
    s_cselect_b32 s46, 7, s46
    s_sub_u32 s46, s46, 1
    s_lshl_b32 s47, s46, 13
    s_add_u32 s47, s47, s45
    buffer_load_dwordx4 v[152:155], v10, s[8:11], s47 offen sc1
    buffer_load_dwordx4 v[156:159], v10, s[8:11], s47 offen offset:1024 sc1
    s_cmp_eq_u32 s46, 0
    s_cselect_b32 s46, 7, s46
    s_sub_u32 s46, s46, 1
    s_lshl_b32 s47, s46, 13
    s_add_u32 s47, s47, s45
    buffer_load_dwordx4 v[160:163], v10, s[8:11], s47 offen sc1
    buffer_load_dwordx4 v[164:167], v10, s[8:11], s47 offen offset:1024 sc1
    s_cmp_eq_u32 s46, 0
    s_cselect_b32 s46, 7, s46
    s_sub_u32 s46, s46, 1
    s_lshl_b32 s47, s46, 13
    s_add_u32 s47, s47, s45
    buffer_load_dwordx4 v[168:171], v10, s[8:11], s47 offen sc1
    buffer_load_dwordx4 v[172:175], v10, s[8:11], s47 offen offset:1024 sc1
    s_cmp_eq_u32 s46, 0
    s_cselect_b32 s46, 7, s46
    s_sub_u32 s46, s46, 1
    s_branch L_k2_loaded
L_k2_others:
    s_barrier
    s_lshl_b32 s47, s46, 13
    s_add_u32 s47, s47, s45
    buffer_load_dwordx4 v[128:131], v10, s[8:11], s47 offen sc1
    buffer_load_dwordx4 v[132:135], v10, s[8:11], s47 offen offset:1024 sc1
    s_cmp_eq_u32 s46, 0
    s_cselect_b32 s46, 7, s46
    s_sub_u32 s46, s46, 1
    s_lshl_b32 s47, s46, 13
    s_add_u32 s47, s47, s45
    buffer_load_dwordx4 v[136:139], v10, s[8:11], s47 offen sc1
    buffer_load_dwordx4 v[140:143], v10, s[8:11], s47 offen offset:1024 sc1
    s_cmp_eq_u32 s46, 0
    s_cselect_b32 s46, 7, s46
    s_sub_u32 s46, s46, 1
    s_lshl_b32 s47, s46, 13
    s_add_u32 s47, s47, s45
    buffer_load_dwordx4 v[144:147], v10, s[8:11], s47 offen sc1
    buffer_load_dwordx4 v[148:151], v10, s[8:11], s47 offen offset:1024 sc1
    s_cmp_eq_u32 s46, 0
    s_cselect_b32 s46, 7, s46
    s_sub_u32 s46, s46, 1
    s_barrier
    s_lshl_b32 s47, s46, 13
    s_add_u32 s47, s47, s45
    buffer_load_dwordx4 v[152:155], v10, s[8:11], s47 offen sc1
    buffer_load_dwordx4 v[156:159], v10, s[8:11], s47 offen offset:1024 sc1
    s_cmp_eq_u32 s46, 0
    s_cselect_b32 s46, 7, s46
    s_sub_u32 s46, s46, 1
    s_lshl_b32 s47, s46, 13
    s_add_u32 s47, s47, s45
    buffer_load_dwordx4 v[160:163], v10, s[8:11], s47 offen sc1
    buffer_load_dwordx4 v[164:167], v10, s[8:11], s47 offen offset:1024 sc1
    s_cmp_eq_u32 s46, 0
    s_cselect_b32 s46, 7, s46
    s_sub_u32 s46, s46, 1
    s_lshl_b32 s47, s46, 13
    s_add_u32 s47, s47, s45
    buffer_load_dwordx4 v[168:171], v10, s[8:11], s47 offen sc1
    buffer_load_dwordx4 v[172:175], v10, s[8:11], s47 offen offset:1024 sc1
    s_cmp_eq_u32 s46, 0
    s_cselect_b32 s46, 7, s46
    s_sub_u32 s46, s46, 1
L_k2_loaded:
    v_and_b32 v2, 15, v1
    s_lshl_b32 s46, s36, 4
    v_add_u32 v3, s46, v2
    v_lshrrev_b32 v4, 3, v3
    v_lshlrev_b32 v4, 10, v4
    v_and_b32 v5, 7, v3
    v_lshl_add_u32 v4, v5, 7, v4
    v_bfe_u32 v5, v3, 1, 3
    v_lshrrev_b32 v6, 4, v1
    v_lshlrev_b32 v7, 1, v6
    v_xor_b32 v5, v5, v7
    v_lshl_add_u32 v4, v5, 4, v4
    s_lshl_b32 s46, s40, 13
    v_add_u32 v4, s46, v4
    v_xor_b32 v5, 16, v4
    ds_read_b128 v[192:195], v4 offset:0
    ds_read_b128 v[196:199], v5 offset:0
    v_mul_u32_u24 v2, 57344, v2
    v_lshl_add_u32 v211, v6, 5, v2
    s_lshl_b32 s46, s36, 12
    s_add_u32 s46, s46, 57600
    v_add_u32 v6, s46, v10
    s_lshl_b32 s46, s36, 10
    s_add_u32 s46, s46, 57600
    v_add_u32 v7, s46, v10
    s_lshl_b32 s47, s40, 7
    s_add_u32 s47, s47, s48
    s_waitcnt vmcnt(11)
    v_dot2c_f32_bf16 v96, v128, v208
    v_dot2c_f32_bf16 v97, v128, v209
    v_dot2c_f32_bf16 v100, v129, v208
    v_dot2c_f32_bf16 v101, v129, v209
    v_dot2c_f32_bf16 v104, v130, v208
    v_dot2c_f32_bf16 v105, v130, v209
    v_dot2c_f32_bf16 v108, v131, v208
    v_dot2c_f32_bf16 v109, v131, v209
    s_waitcnt vmcnt(10)
    v_dot2c_f32_bf16 v98, v132, v208
    v_dot2c_f32_bf16 v99, v132, v209
    v_dot2c_f32_bf16 v102, v133, v208
    v_dot2c_f32_bf16 v103, v133, v209
    v_dot2c_f32_bf16 v106, v134, v208
    v_dot2c_f32_bf16 v107, v134, v209
    v_dot2c_f32_bf16 v110, v135, v208
    v_dot2c_f32_bf16 v111, v135, v209
    s_waitcnt vmcnt(9)
    v_dot2c_f32_bf16 v96, v136, v208
    v_dot2c_f32_bf16 v97, v136, v209
    v_dot2c_f32_bf16 v100, v137, v208
    v_dot2c_f32_bf16 v101, v137, v209
    v_dot2c_f32_bf16 v104, v138, v208
    v_dot2c_f32_bf16 v105, v138, v209
    v_dot2c_f32_bf16 v108, v139, v208
    v_dot2c_f32_bf16 v109, v139, v209
    s_waitcnt vmcnt(8)
    v_dot2c_f32_bf16 v98, v140, v208
    v_dot2c_f32_bf16 v99, v140, v209
    v_dot2c_f32_bf16 v102, v141, v208
    v_dot2c_f32_bf16 v103, v141, v209
    v_dot2c_f32_bf16 v106, v142, v208
    v_dot2c_f32_bf16 v107, v142, v209
    v_dot2c_f32_bf16 v110, v143, v208
    v_dot2c_f32_bf16 v111, v143, v209
    s_waitcnt vmcnt(7)
    v_dot2c_f32_bf16 v96, v144, v208
    v_dot2c_f32_bf16 v97, v144, v209
    v_dot2c_f32_bf16 v100, v145, v208
    v_dot2c_f32_bf16 v101, v145, v209
    v_dot2c_f32_bf16 v104, v146, v208
    v_dot2c_f32_bf16 v105, v146, v209
    v_dot2c_f32_bf16 v108, v147, v208
    v_dot2c_f32_bf16 v109, v147, v209
    s_waitcnt vmcnt(6)
    v_dot2c_f32_bf16 v98, v148, v208
    v_dot2c_f32_bf16 v99, v148, v209
    v_dot2c_f32_bf16 v102, v149, v208
    v_dot2c_f32_bf16 v103, v149, v209
    v_dot2c_f32_bf16 v106, v150, v208
    v_dot2c_f32_bf16 v107, v150, v209
    v_dot2c_f32_bf16 v110, v151, v208
    v_dot2c_f32_bf16 v111, v151, v209
    s_waitcnt vmcnt(5)
    v_dot2c_f32_bf16 v96, v152, v208
    v_dot2c_f32_bf16 v97, v152, v209
    v_dot2c_f32_bf16 v100, v153, v208
    v_dot2c_f32_bf16 v101, v153, v209
    v_dot2c_f32_bf16 v104, v154, v208
    v_dot2c_f32_bf16 v105, v154, v209
    v_dot2c_f32_bf16 v108, v155, v208
    v_dot2c_f32_bf16 v109, v155, v209
    s_waitcnt vmcnt(4)
    v_dot2c_f32_bf16 v98, v156, v208
    v_dot2c_f32_bf16 v99, v156, v209
    v_dot2c_f32_bf16 v102, v157, v208
    v_dot2c_f32_bf16 v103, v157, v209
    v_dot2c_f32_bf16 v106, v158, v208
    v_dot2c_f32_bf16 v107, v158, v209
    v_dot2c_f32_bf16 v110, v159, v208
    v_dot2c_f32_bf16 v111, v159, v209
    s_waitcnt vmcnt(3)
    v_dot2c_f32_bf16 v96, v160, v208
    v_dot2c_f32_bf16 v97, v160, v209
    v_dot2c_f32_bf16 v100, v161, v208
    v_dot2c_f32_bf16 v101, v161, v209
    v_dot2c_f32_bf16 v104, v162, v208
    v_dot2c_f32_bf16 v105, v162, v209
    v_dot2c_f32_bf16 v108, v163, v208
    v_dot2c_f32_bf16 v109, v163, v209
    s_waitcnt vmcnt(2)
    v_dot2c_f32_bf16 v98, v164, v208
    v_dot2c_f32_bf16 v99, v164, v209
    v_dot2c_f32_bf16 v102, v165, v208
    v_dot2c_f32_bf16 v103, v165, v209
    v_dot2c_f32_bf16 v106, v166, v208
    v_dot2c_f32_bf16 v107, v166, v209
    v_dot2c_f32_bf16 v110, v167, v208
    v_dot2c_f32_bf16 v111, v167, v209
    s_waitcnt vmcnt(1)
    v_dot2c_f32_bf16 v96, v168, v208
    v_dot2c_f32_bf16 v97, v168, v209
    v_dot2c_f32_bf16 v100, v169, v208
    v_dot2c_f32_bf16 v101, v169, v209
    v_dot2c_f32_bf16 v104, v170, v208
    v_dot2c_f32_bf16 v105, v170, v209
    v_dot2c_f32_bf16 v108, v171, v208
    v_dot2c_f32_bf16 v109, v171, v209
    s_waitcnt vmcnt(0)
    v_dot2c_f32_bf16 v98, v172, v208
    v_dot2c_f32_bf16 v99, v172, v209
    v_dot2c_f32_bf16 v102, v173, v208
    v_dot2c_f32_bf16 v103, v173, v209
    v_dot2c_f32_bf16 v106, v174, v208
    v_dot2c_f32_bf16 v107, v174, v209
    v_dot2c_f32_bf16 v110, v175, v208
    v_dot2c_f32_bf16 v111, v175, v209
    ds_write_b128 v6, v[96:99] offset:0
    ds_write_b128 v6, v[100:103] offset:1024
    ds_write_b128 v6, v[104:107] offset:2048
    ds_write_b128 v6, v[108:111] offset:3072
    s_waitcnt lgkmcnt(0)
    s_barrier
    ds_read_b128 v[176:179], v7 offset:0
    ds_read_b128 v[180:183], v7 offset:4096
    ds_read_b128 v[184:187], v7 offset:8192
    ds_read_b128 v[188:191], v7 offset:12288
    s_waitcnt lgkmcnt(0)
    v_lshlrev_b32 v2, 16, v192
    v_and_b32 v3, 0xffff0000, v192
    v_fma_f32 v2, v176, v210, v2
    v_fma_f32 v3, v180, v210, v3
    v_cvt_pk_bf16_f32 v200, v2, v3
    v_lshlrev_b32 v2, 16, v193
    v_and_b32 v3, 0xffff0000, v193
    v_fma_f32 v2, v184, v210, v2
    v_fma_f32 v3, v188, v210, v3
    v_cvt_pk_bf16_f32 v201, v2, v3
    v_lshlrev_b32 v2, 16, v194
    v_and_b32 v3, 0xffff0000, v194
    v_fma_f32 v2, v177, v210, v2
    v_fma_f32 v3, v181, v210, v3
    v_cvt_pk_bf16_f32 v202, v2, v3
    v_lshlrev_b32 v2, 16, v195
    v_and_b32 v3, 0xffff0000, v195
    v_fma_f32 v2, v185, v210, v2
    v_fma_f32 v3, v189, v210, v3
    v_cvt_pk_bf16_f32 v203, v2, v3
    v_lshlrev_b32 v2, 16, v196
    v_and_b32 v3, 0xffff0000, v196
    v_fma_f32 v2, v178, v210, v2
    v_fma_f32 v3, v182, v210, v3
    v_cvt_pk_bf16_f32 v204, v2, v3
    v_lshlrev_b32 v2, 16, v197
    v_and_b32 v3, 0xffff0000, v197
    v_fma_f32 v2, v186, v210, v2
    v_fma_f32 v3, v190, v210, v3
    v_cvt_pk_bf16_f32 v205, v2, v3
    v_lshlrev_b32 v2, 16, v198
    v_and_b32 v3, 0xffff0000, v198
    v_fma_f32 v2, v179, v210, v2
    v_fma_f32 v3, v183, v210, v3
    v_cvt_pk_bf16_f32 v206, v2, v3
    v_lshlrev_b32 v2, 16, v199
    v_and_b32 v3, 0xffff0000, v199
    v_fma_f32 v2, v187, v210, v2
    v_fma_f32 v3, v191, v210, v3
    v_cvt_pk_bf16_f32 v207, v2, v3
    buffer_store_dwordx4 v[200:203], v211, s[16:19], s47 offen offset:0
    buffer_store_dwordx4 v[204:207], v211, s[16:19], s47 offen offset:16
L_k2_end:
    s_endpgm

L_code_end:
.p2align 2
L_cs_table:
.long 0x34ee8000, 0x354ec000, 0xb5070000, 0x34f98000, 0x35dac000, 0xb50f0000, 0x3501c000, 0x35eae000
.long 0x35890000, 0x368d9000, 0xba00b0c0, 0xb51f0000, 0x3a005bc0, 0xb6071000, 0xb4000000, 0xb6ed0800
.long 0xb64c8000, 0xb6368000, 0x35040000, 0x371d7000, 0xb6962000, 0xb5c2c000, 0xb6368000, 0xb5350000
.long 0x36b16000, 0x372e4800, 0xba000f00, 0x38818080, 0x363b0000, 0x373c0000, 0xb9fece00, 0x00000000
.long 0xb9e1dd00, 0x3739a000, 0x3857cc00, 0xb62d0000, 0xb9ff2c00, 0x3770c000, 0x39ffd600, 0x38529c00
.long 0x36e00000, 0x385ca400, 0x36ca2000, 0x357c8000, 0x368c0000, 0x36c89c00, 0x35700000, 0x387c7c00
.long 0x38392580, 0x37f85800, 0x38872c00, 0x375d8800, 0x36e34000, 0xb746c000, 0xb5e58000, 0x393634e0
.long 0x3a0f1e80, 0xba81c580, 0x3891a800, 0xb7e40000, 0x3a047600, 0x3b7f0c00, 0xb7b3f000, 0x00000000
.long 0xb8a17500, 0x3784b000, 0xba027780, 0xba79b180, 0x38893000, 0x38338100, 0x353c0000, 0xb61d8000
.long 0x39fcf900, 0xb6965800, 0x382d4000, 0x37402000, 0x374ac800, 0xbb00c940, 0xbb809008, 0x3894a080
.long 0xb84d6000, 0xbb7da040, 0xba09d500, 0x389d5400, 0x3a428300, 0x3a7d2c40, 0xbabf9700, 0x3817b200
.long 0x39bfb440, 0xb7ba8000, 0x38b4b100, 0x37c4e700, 0x3b90a5e0, 0x3ba04ee0, 0x3bbfc400, 0x00000000
.long 0x37d10000, 0xb86eba80, 0xbb20cd60, 0x37911800, 0x383e0000, 0x3a41ca80, 0xb9e11800, 0x38a77100
.long 0xb5700000, 0xba7a7180, 0x37070000, 0x399d8a00, 0x3a8f4400, 0xb887a600, 0xba333a00, 0x3a0040d8
.long 0x3b5ef920, 0x3bb78710, 0x3876c000, 0xba860c80, 0x39928200, 0x3b810e20, 0x37aca000, 0xb89a2000
.long 0xbb912d40, 0x392ba800, 0x3b112f80, 0x3b0ed800, 0x37fe0000, 0x3915c200, 0xbb7f24e0, 0x00000000
.long 0xb9d58400, 0x3b2ee858, 0xbb8b3e00, 0xba29ba80, 0x37bd9000, 0x3a808840, 0x3a48b400, 0xb73ac000
.long 0x387f3c00, 0xb8edb000, 0xbb809400, 0xb814b700, 0x3a86a500, 0xba9ad380, 0xba61f400, 0x38fbd400
.long 0xb9aab400, 0x3ba31f90, 0x38152000, 0xb9a8a960, 0x3a67f200, 0x3b3eeb00, 0x3a81ab80, 0xb7cd7000
.long 0x3b425400, 0xb8861700, 0x3ac0ff80, 0xb814dc00, 0x3abb5580, 0xbc04d004, 0xbba36ac0, 0x00000000
.long 0x37a0a700, 0x3b8e0a40, 0xbb252a00, 0xba770100, 0xbaa75600, 0xbb0aeb40, 0x3993f000, 0x393db180
.long 0x3a9157a0, 0x39241200, 0x3b162960, 0xbab5d7e0, 0xbb8e7f40, 0xba7a5600, 0x389d9200, 0xb8a11700
.long 0xb7290000, 0x3bbbf644, 0x3b337d80, 0x39713000, 0xbb265300, 0xb79cd400, 0xba7b6200, 0x38751380
.long 0x3b6e0254, 0x3aff2f80, 0xbad65a00, 0xbb0e4640, 0xb866b000, 0x3ba00a00, 0x3993d000, 0x00000000
.long 0xbbd0a900, 0xba837800, 0xbb6bda00, 0xb94f96a0, 0xb92fa800, 0x3b0962a0, 0x3aa3a000, 0xb9e3bb80
.long 0xbb3ca500, 0x3b71f000, 0xb6510000, 0x3a039680, 0xba713d00, 0x3c16ee40, 0xbac9b800, 0x38beab00
.long 0xbb80fd00, 0x38270000, 0xbb9698c0, 0xbaa176c0, 0x3b525dc0, 0xbb09f2c0, 0xb9787000, 0xb856b000
.long 0x3b7c8f00, 0x3b4f4800, 0x39e11700, 0xb88f4600, 0xbb997c00, 0xb9ccf400, 0xbb623200, 0x00000000
.long 0x33bc0000, 0x356e8000, 0x35830000, 0x351d8000, 0x35350000, 0x35870000, 0xb6562000, 0xb6002000
.long 0xb9fef600, 0x365ac000, 0xb59f0000, 0x358f0000, 0x3a005c80, 0xb5f74000, 0xb9fdf000, 0x35398000
.long 0x36340000, 0x36090000, 0x3a016000, 0x35590000, 0xb72d2000, 0x36b0c000, 0x3a7fb700, 0xb76d2000
.long 0xb9ff3b00, 0x36378000, 0x36870000, 0xb7b9b400, 0x3a01ba00, 0x34800000, 0x37190000, 0xb8839d00
.long 0x36890000, 0xb6cc8000, 0xb7982000, 0xb75b4000, 0x3a026800, 0xb5840000, 0x3a011400, 0xb7a2a000
.long 0x37700000, 0xb88d4c00, 0xb9ff2700, 0x3641c000, 0xb9fdd000, 0x36b68000, 0x36e20000, 0xb89d3c00
.long 0xb8191400, 0x37316000, 0x39fe3600, 0x36b96000, 0xb5640000, 0x34f00000, 0x3a007280, 0xb9619380
.long 0x3a808f00, 0x36bb0000, 0xb9fc6c00, 0xb7bc0000, 0x371d0000, 0xb6990000, 0xb845e000, 0xba0a77c0
.long 0xb54b0000, 0x38f11800, 0x3a007900, 0x36e58000, 0x39e24800, 0xb8700800, 0x3a01d000, 0xb7eb4000
.long 0x3a027c00, 0x36540000, 0xba7cd800, 0xb7608000, 0x37ba3800, 0x35280000, 0xb9ff0100, 0xb8bd3400
.long 0x36960000, 0x37600000, 0xb9fc5400, 0xb93e4a00, 0x38682000, 0xb74a2000, 0x39e66000, 0x37f04800
.long 0x39ffb480, 0xbb83ba00, 0xb75d7000, 0xb96c99c0, 0x36990000, 0xbb401e00, 0x38af0000, 0xb94e6e00
.long 0x39f51000, 0xb7e70600, 0xb9e19600, 0xbaa03a40, 0x383e0000, 0xba61cb00, 0xba7f7400, 0xb8a8ae00
.long 0xb8e60000, 0x3b8071a0, 0x3b963c80, 0x37c6c000, 0xbb045c00, 0x3b003960, 0x3a819e00, 0xb98b1560
.long 0xb9e03200, 0xbb843860, 0xbb816e00, 0xb8716000, 0xbb5fb080, 0x38dcb000, 0x380e3000, 0xb81b0000
.long 0xbb3f5b00, 0x3be11d80, 0x3a074000, 0x3a9fd400, 0xb7820000, 0xb69e8000, 0x3bbe1320, 0xba8a77c0
.long 0x3b575100, 0xbb2a1750, 0x3b307c00, 0xb95edc00, 0xb7cbe000, 0x3b013bc0, 0xba4cb800, 0x361b0000
.long 0xba300c40, 0xbadeda00, 0x3b612800, 0xb8dbd100, 0xbb5fad00, 0x3b3fe880, 0xbb914100, 0x380c7000
.long 0xbb6f5700, 0xb741c000, 0x389a1000, 0x3a6da960, 0x3a13fc00, 0x3b0a9600, 0x3a38a000, 0x37c12000
.long 0xb90ac000, 0x388d7200, 0x3b507f80, 0xb88d1000, 0x3ad75500, 0x3ba12010, 0x3b64d500, 0xb932d880
.long 0x37c1b200, 0xbb066b00, 0xbb8e6a00, 0xba867f00, 0x3b245600, 0xba962b00, 0xbb2a8000, 0xb8db6000
.long 0x3bb15600, 0x3a650600, 0xbb3c2940, 0xbaf52940, 0x3a040800, 0xbb486900, 0x386b3800, 0x38a87a00
.long 0xbb20a800, 0x3b0fed10, 0x3a020c00, 0xb96e6000, 0x3abb5c00, 0x38890a00, 0xbb809400, 0x383c4700
.long 0x3b180358, 0xba35a200, 0xbb62d200, 0xb79ec000, 0x389b3000, 0x3b40f000, 0xba21f000, 0xba9dde80
.long 0x3b20b000, 0xbb9e5e00, 0xba089000, 0xb8922280, 0xba03ec00, 0xbbe332a0, 0xbb77d000, 0x38123800
.long 0x3b515a00, 0x3ba6f800, 0xb89f1000, 0xba739100, 0x3b91d840, 0xba8f7400, 0xba5c9000, 0x39374500
.long 0xbb49f800, 0xb8bbc000, 0x38e62000, 0xb989ce00, 0x3b505c80, 0x3bf37900, 0xba8cf000, 0xb857a000
.long 0xb7e38000, 0x3ba3a200, 0xba608b00, 0xb9bc3100, 0x3ada1000, 0x3b399d00, 0xbaab9800, 0xb98041a0
.section .rodata,"a"
.p2align 6
.amdhsa_kernel fnet_k1_kernel
  .amdhsa_next_free_vgpr 224
  .amdhsa_next_free_sgpr 102
  .amdhsa_accum_offset 224
  .amdhsa_group_segment_fixed_size 0
  .amdhsa_kernarg_size 88
  .amdhsa_user_sgpr_count 2
  .amdhsa_user_sgpr_kernarg_segment_ptr 1
  .amdhsa_system_sgpr_workgroup_id_x 1
  .amdhsa_float_denorm_mode_32 3
.end_amdhsa_kernel
.p2align 6
.amdhsa_kernel fnet_k2_kernel
  .amdhsa_next_free_vgpr 512
  .amdhsa_next_free_sgpr 102
  .amdhsa_accum_offset 256
  .amdhsa_group_segment_fixed_size 0
  .amdhsa_kernarg_size 88
  .amdhsa_user_sgpr_count 2
  .amdhsa_user_sgpr_kernarg_segment_ptr 1
  .amdhsa_system_sgpr_workgroup_id_x 1
  .amdhsa_float_denorm_mode_32 3
.end_amdhsa_kernel
```
